```python
import torch

def _softmax(x, axis=-1):
    return torch.softmax(x, dim=axis)
def _gelu(x):
    return torch.nn.functional.gelu(x, approximate="tanh")
def _silu(x):
    return torch.nn.functional.silu(x)
def _sigmoid(x):
    return torch.sigmoid(x)
def _layernorm(x, axis=-1, eps=1e-5):
    m = x.mean(dim=axis, keepdim=True)
    v = x.var(dim=axis, keepdim=True, unbiased=False)
    return (x - m) / torch.sqrt(v + eps)
def _scatter_add(tgt, idx, src, axis=0):
    return tgt.clone().index_add_(axis, idx, src)
def _segment_sum(src, seg, n):
    out = torch.zeros((n,) + src.shape[1:], dtype=src.dtype)
    return out.index_add_(0, seg, src)
def _pad(x, pw):
    flat = tuple(v for pair in reversed(pw) for v in pair)
    return torch.nn.functional.pad(x, flat)

kernel_name = 'sequential_preLN__spectral_fnet__moe_arch_mod__prompt'

def setup_inputs():

    _w = (lambda a: (lambda t: t.to(torch.bfloat16) if t.is_floating_point() else t)(torch.as_tensor(a)))
    def _A_setup():
        B, S, D = 1, 2048, 640
        ns = torch.arange(S)[:, None] * torch.arange(S)[None, :]
        nd = torch.arange(D)[:, None] * torch.arange(D)[None, :]
        Ws_re = torch.cos(-2.0 * torch.pi * ns / S).to(float)
        Ws_im = torch.sin(-2.0 * torch.pi * ns / S).to(float)
        Wd_re = torch.cos(-2.0 * torch.pi * nd / D).to(float)
        Wd_im = torch.sin(-2.0 * torch.pi * nd / D).to(float)
        return {
            "x": _w((lambda *s: torch.randn(*s, dtype=torch.bfloat16) * 0.1)(B, S, D)),
            "dft_seq_re": _w(Ws_re),
            "dft_seq_im": _w(Ws_im),
            "dft_hid_re": _w(Wd_re),
            "dft_hid_im": _w(Wd_im),
        }
    _A_in = _A_setup()

    def _B_setup():
        B, S, D, F, C = 1, 2048, 640, 1728, 8
        return {
            "x": _w((lambda *s: torch.randn(*s, dtype=torch.bfloat16) * 0.1)(B, S, D)),
            "w_r": _w((lambda *s: torch.randn(*s, dtype=torch.bfloat16) * 1.6)(D)),
            "w_gate": _w((lambda *s: torch.randn(*s, dtype=torch.bfloat16) * 0.8)(D, F)),
            "w_up": _w((lambda *s: torch.randn(*s, dtype=torch.bfloat16) * 0.8)(D, F)),
            "w_down": _w((lambda *s: torch.randn(*s, dtype=torch.bfloat16) * 0.8)(F, D)),
        }
    _B_in = _B_setup()

    return {
        "A_x": _A_in["x"],
        "A_dft_seq_re": _A_in["dft_seq_re"],
        "A_dft_seq_im": _A_in["dft_seq_im"],
        "A_dft_hid_re": _A_in["dft_hid_re"],
        "A_dft_hid_im": _A_in["dft_hid_im"],
        "B_x": _B_in["x"],
        "B_w_r": _B_in["w_r"],
        "B_w_gate": _B_in["w_gate"],
        "B_w_up": _B_in["w_up"],
        "B_w_down": _B_in["w_down"],
    }

def reference(A_x, A_dft_seq_re, A_dft_seq_im, A_dft_hid_re, A_dft_hid_im, B_x, B_w_r, B_w_gate, B_w_up, B_w_down):
    def _A_ref(x, dft_seq_re, dft_seq_im, dft_hid_re, dft_hid_im):
        a = torch.einsum("bsd,ed->bse", x, dft_hid_re)
        b = torch.einsum("bsd,ed->bse", x, dft_hid_im)
        y = torch.einsum("ts,bse->bte", dft_seq_re, a) - torch.einsum("ts,bse->bte", dft_seq_im, b)
        return y

    def _B_ref(x, w_r, w_gate, w_up, w_down):
        B, S, D = x.shape
        C = 8
        r = x @ w_r
        idx = torch.argsort(-r, axis=-1)[:, :C]
        idx_e = (lambda x, n, axis: torch.repeat_interleave(x, n, dim=axis))(idx.reshape(B, C, 1), D, axis=2)
        x_sel = (lambda x, i, axis: torch.take_along_dim(x, i, dim=axis))(x, idx_e, axis=1)
        g = _silu(x_sel @ w_gate)
        u = x_sel @ w_up
        y = (g * u) @ w_down
        r_sel = _sigmoid((lambda x, i, axis: torch.take_along_dim(x, i, dim=axis))(r, idx, axis=1))
        y = y * r_sel.reshape(B, C, 1)
        b_off = (torch.arange(B) * S).reshape(B, 1)
        flat_idx = (idx + b_off).reshape(B * C)
        zero = (x * 0.0).reshape(B * S, D)
        upd = _scatter_add(zero, flat_idx, y.reshape(B * C, D), axis=0)
        return x + upd.reshape(B, S, D)

    x = A_x
    h = x + _A_ref(_layernorm(x, axis=-1), A_dft_seq_re, A_dft_seq_im, A_dft_hid_re, A_dft_hid_im)
    h2 = h + _B_ref(_layernorm(h, axis=-1), B_w_r, B_w_gate, B_w_up, B_w_down)
    return h2
```

```asm
; @launch grid=(256,1,1) block=(704,1,1) lds=139328
.amdgcn_target "amdgcn-amd-amdhsa--gfx950"
.text
.globl sequential_preLN__spectral_fnet__moe_arch_mod__prompt_kernel
.p2align 8
.type sequential_preLN__spectral_fnet__moe_arch_mod__prompt_kernel,@function
sequential_preLN__spectral_fnet__moe_arch_mod__prompt_kernel:
s_load_dwordx2 s[16:17], s[0:1], 0
v_lshrrev_b32 v4, 6, v0
s_cmp_eq_u32 s2, 0
s_cselect_b32 s4, 7, 8
v_readfirstlane_b32 s3, v4
s_lshr_b32 s7, s2, 7
s_cbranch_scc1 L_bf
s_setprio 3
v_lshlrev_b32 v4, s4, v4
v_add_u32 v4, s2, v4
v_sub_u32 v5, 2048, v4
v_and_b32 v7, 8, v0
v_cmp_ne_u32 vcc, 0, v7
v_lshrrev_b32 v7, 11, v5
v_lshrrev_b32 v5, v7, v5
v_cndmask_b32 v159, v4, v5, vcc
v_mul_u32_u24 v158, 1280, v159
v_and_b32 v7, 48, v0
v_and_b32 v6, 7, v0
v_lshl_add_u32 v158, v7, 2, v158
v_lshl_add_u32 v158, v6, 3, v158
s_cmp_ge_u32 s3, 8
s_cbranch_scc1 L_nox
s_waitcnt lgkmcnt(0)
global_load_dwordx2 v[8:9], v158, s[16:17] offset:0
global_load_dwordx2 v[10:11], v158, s[16:17] offset:256
global_load_dwordx2 v[12:13], v158, s[16:17] offset:512
global_load_dwordx2 v[14:15], v158, s[16:17] offset:768
global_load_dwordx2 v[16:17], v158, s[16:17] offset:1024
s_branch L_nox
L_bf:
s_load_dwordx2 s[40:41], s[0:1], 96
s_getpc_b64 s[42:43]
L_pc:
s_cmp_lg_u32 s3, 0
s_cbranch_scc1 L_bf0
s_bfe_u32 s4, s2, 0x30003
s_mulk_i32 s4, 3072
v_lshrrev_b32 v4, 1, v0
v_lshl_add_u32 v4, v4, 7, s4
v_min_u32 v4, T_end-L_pc-4, v4
global_load_dword v22, v4, s[42:43]
L_bf0:
v_and_b32 v6, 7, v0
s_load_dwordx4 s[28:31], s[0:1], 48
s_load_dwordx8 s[32:39], s[0:1], 64
s_cmp_ge_u32 s2, 256
s_cbranch_scc1 L_end
v_and_b32 v1, 63, v0
v_lshrrev_b32 v2, 4, v1
v_and_b32 v3, 15, v0
v_lshlrev_b32 v157, 4, v1
s_bfe_u32 s5, s2, 0x10003
s_mov_b32 s15, 0
s_add_u32 s42, s42, T_0-L_pc
s_addc_u32 s43, s43, 0
s_sub_u32 s4, s2, 128
v_mov_b32 v12, -1
v_mov_b32 v13, -1
v_mov_b32 v14, -1
v_mov_b32 v15, -1
s_cmp_lg_u32 s3, 10
s_cbranch_scc1 L_bf1
s_lshl_b32 s7, s4, 7
s_add_u32 s7, s7, 65536
v_add_u32 v5, s7, v157
s_mul_i32 s7, s4, 1664
s_add_u32 s7, s7, 2752512
v_add_u32 v7, s7, v157
v_min_u32 v4, 9, v1
v_lshlrev_b32 v4, 7, v4
s_waitcnt lgkmcnt(0)
global_load_dword v22, v4, s[28:29]
global_store_dwordx4 v7, v[12:15], s[40:41] offset:640 sc1
s_mov_b64 exec, 0xff
s_branch L_bf2
L_bf1:
s_lshl_b32 s7, s3, 7
s_add_u32 s7, s7, s4
s_lshl_b32 s7, s7, 7
s_add_u32 s7, s7, 131072
v_lshrrev_b32 v5, 3, v1
v_mul_u32_u24 v5, 0x28000, v5
v_lshl_add_u32 v5, v6, 4, v5
v_add_u32 v5, s7, v5
s_mul_i32 s7, s4, 10
s_add_u32 s7, s7, s3
s_lshl_b32 s7, s7, 10
s_add_u32 s7, s7, 1441792
v_add_u32 v7, s7, v157
L_bf2:
s_waitcnt lgkmcnt(0)
s_load_dword s6, s[40:41], 0
global_store_dwordx4 v5, v[12:15], s[40:41] sc1
s_mov_b64 exec, -1
s_barrier
global_store_dwordx4 v7, v[12:15], s[40:41] sc1
s_and_b32 s7, s2, 7
s_lshl1_add_u32 s7, s7, s5
s_add_u32 s8, s7, 208
s_add_u32 s9, s7, 242
s_cmp_lt_u32 s7, 6
s_cselect_b32 s8, s8, s9
s_sub_u32 s9, 229, s7
s_cmp_ge_u32 s7, 14
s_cselect_b32 s8, s9, s8
s_cmp_lt_u32 s2, 208
s_cselect_b32 s14, s2, s8
s_sub_u32 s9, s2, 8
s_cmp_ge_u32 s2, 224
s_cselect_b32 s14, s9, s14
s_lshl_b32 s7, s4, 7
s_add_u32 s7, s7, 32768
v_add_u32 v18, s7, v157
v_lshrrev_b32 v4, 3, v1
v_lshlrev_b32 v19, 15, v4
v_lshrrev_b32 v4, 1, v4
v_lshl_add_u32 v19, v4, 15, v19
v_lshl_add_u32 v19, v6, 4, v19
s_sub_u32 s7, s7, 0x4000
v_add_u32 v19, s7, v19
s_waitcnt lgkmcnt(0)
s_add_u32 s6, s6, 1
v_mov_b32 v8, s6
v_mov_b32 v9, s6
v_mov_b32 v10, s6
v_mov_b32 v11, s6
s_waitcnt vmcnt(1)
s_barrier
s_sub_u32 s49, s14, 160
s_cmp_lt_u32 s49, 54
s_cselect_b32 s7, s3, 9
s_cmp_lt_u32 s7, 8
s_cbranch_scc1 L_f1
s_cmp_lg_u32 s3, 9
s_cbranch_scc1 L_bf9
s_mov_b64 exec, 0xffffff
global_store_dwordx4 v19, v[8:11], s[40:41] sc1
s_mov_b64 exec, -1
s_waitcnt vmcnt(1)
s_branch L_bfa
L_bf9:
s_waitcnt vmcnt(0)
L_bfa:
s_barrier
s_cmp_lg_u32 s3, 10
s_cbranch_scc1 L_bfb
s_mov_b64 exec, 0xff
global_store_dwordx4 v18, v[8:11], s[40:41] sc1
s_mov_b64 exec, -1
L_bfb:
s_barrier
s_setprio 0
s_cmp_lt_u32 s3, 8
s_cbranch_scc1 L_bf3
s_cmp_lt_u32 s3, 10
s_cbranch_scc1 L_bf8
s_cmp_lt_u32 s4, 16
s_cbranch_scc1 L_agg
s_cmp_lt_u32 s2, 160
s_cbranch_scc1 L_flagchk
s_and_b32 s7, s14, 254
s_cmp_eq_u32 s7, 214
s_cbranch_scc1 L_fin
s_branch L_fw
L_nox:
s_setprio 0
s_load_dwordx2 s[40:41], s[0:1], 96
s_load_dwordx4 s[28:31], s[0:1], 48
s_load_dwordx8 s[32:39], s[0:1], 64
s_getpc_b64 s[42:43]
L_pc2:
v_and_b32 v1, 63, v0
v_lshrrev_b32 v2, 4, v1
v_and_b32 v3, 15, v0
v_lshlrev_b32 v157, 4, v1
s_bfe_u32 s5, s2, 0x10003
s_mov_b32 s15, 0
s_add_u32 s42, s42, T_0-L_pc2
s_addc_u32 s43, s43, 0
s_cmp_eq_u32 s3, 10
s_cbranch_scc1 L_a10
v_readfirstlane_b32 s46, v4
v_readfirstlane_b32 s47, v5
s_lshl_b32 s48, s3, 1
s_cmp_eq_u32 s3, 8
s_cselect_b32 s48, 1, s48
s_and_b32 s50, s46, 1023
v_bfe_u32 v20, v0, 2, 1
v_bfe_u32 v21, v0, 3, 2
v_and_b32 v22, 3, v0
v_lshl_add_u32 v24, v21, 2, v22
v_lshl_add_u32 v24, v20, 4, v24
v_mul_u32_u24 v24, 20, v24
v_add_u32 v24, s3, v24
s_cmp_lg_u32 s3, 0
s_cbranch_scc1 L_wg
v_lshrrev_b32 v24, 1, v21
v_lshl_add_u32 v24, v20, 1, v24
v_lshl_add_u32 v24, v24, 2, v22
v_and_b32 v21, 1, v21
v_lshl_add_u32 v24, v24, 1, 2
v_sub_u32 v24, v24, v21
v_mul_u32_u24 v24, 10, v24
L_wg:
v_sub_u32 v25, 640, v24
v_cmp_eq_u32 vcc, 320, v24
v_lshrrev_b32 v20, 5, v1
v_and_b32 v21, 31, v0
v_cndmask_b32_e64 v25, v25, 0, vcc
v_cmp_eq_u32 vcc, 1, v20
s_mul_i32 s49, s3, 72
v_lshl_add_u32 v115, v21, 1, s49
v_cndmask_b32 v24, v24, v25, vcc
v_lshlrev_b32 v87, 1, v24
v_mul_u32_u24 v20, 720, v20
v_add_u32 v115, v115, v20
s_cmp_ge_u32 s3, 8
s_cbranch_scc1 L_gtrig
v_lshrrev_b32 v161, 8, v159
v_bfe_u32 v4, v159, 7, 1
v_lshl_add_u32 v161, v4, 3, v161
v_lshrrev_b32 v4, 2, v161
v_sub_u32 v4, 0, v4
v_and_b32 v4, 3, v4
v_lshlrev_b32 v4, 1, v4
v_xor_b32 v4, v4, v6
v_mul_u32_u24 v160, 5120, v2
v_lshl_add_u32 v160, v4, 3, v160
v_lshl_add_u32 v160, v161, 6, v160
v_lshlrev_b32 v161, 2, v161
v_mov_b32 v23, 0
v_mov_b32 v27, 0
v_mov_b32 v31, 0
v_mov_b32 v35, 0
v_mov_b32 v18, 0
v_mov_b32 v19, 0
s_mov_b32 s52, 0x05040100
s_mov_b32 s53, 0x07060302
ds_write_b32 v161, v23 offset:21952
v_add_lshl_u32 v86, v161, v2, 2
v_mov_b32 v162, 0xbd000000
v_cmp_eq_u32 vcc, 0, v2
s_nop 1
v_cndmask_b32 v162, 0, v162, vcc
L_gtrig:
s_add_u32 s12, s3, 80
s_cmp_eq_u32 s3, 0
s_cselect_b32 s13, 4, 8
s_cselect_b32 s14, 20, s3
s_cselect_b32 s12, 10, s12
v_lshrrev_b32 v44, 2, v3
v_and_b32 v45, 3, v0
v_mad_u32_u24 v44, v44, s13, v45
v_mul_u32_u24 v44, 20, v44
v_add_u32 v45, s12, v44
v_add_u32 v44, s14, v44
v_lshlrev_b32 v46, 3, v2
v_cvt_f32_u32 v44, v44
v_cvt_f32_u32 v45, v45
v_cvt_f32_u32 v46, v46
v_mul_f32 v44, 0x3acccccd, v44
v_mul_f32 v45, 0x3acccccd, v45
v_mul_f32 v47, v46, v45
v_mul_f32 v46, v46, v44
v_cos_f32 v48, v46
v_sin_f32 v49, v46
v_add_f32 v46, v46, v44
v_cos_f32 v64, v44
v_cos_f32 v50, v46
v_sin_f32 v51, v46
v_add_f32 v64, v64, v64
v_pk_fma_f32 v[52:53], v[50:51], v[64:65], v[48:49] op_sel_hi:[1,0,1] neg_lo:[0,0,1] neg_hi:[0,0,1]
v_pk_fma_f32 v[54:55], v[52:53], v[64:65], v[50:51] op_sel_hi:[1,0,1] neg_lo:[0,0,1] neg_hi:[0,0,1]
v_pk_fma_f32 v[56:57], v[54:55], v[64:65], v[52:53] op_sel_hi:[1,0,1] neg_lo:[0,0,1] neg_hi:[0,0,1]
v_pk_fma_f32 v[58:59], v[56:57], v[64:65], v[54:55] op_sel_hi:[1,0,1] neg_lo:[0,0,1] neg_hi:[0,0,1]
v_pk_fma_f32 v[60:61], v[58:59], v[64:65], v[56:57] op_sel_hi:[1,0,1] neg_lo:[0,0,1] neg_hi:[0,0,1]
v_pk_fma_f32 v[62:63], v[60:61], v[64:65], v[58:59] op_sel_hi:[1,0,1] neg_lo:[0,0,1] neg_hi:[0,0,1]
v_cvt_pk_bf16_f32 v88, v48, v50
v_cvt_pk_bf16_f32 v104, v49, v51
v_xor_b32 v92, 0x80008000, v104
v_cvt_pk_bf16_f32 v89, v52, v54
v_cvt_pk_bf16_f32 v105, v53, v55
v_xor_b32 v93, 0x80008000, v105
v_cvt_pk_bf16_f32 v90, v56, v58
v_cvt_pk_bf16_f32 v106, v57, v59
v_xor_b32 v94, 0x80008000, v106
v_cvt_pk_bf16_f32 v91, v60, v62
v_cvt_pk_bf16_f32 v107, v61, v63
v_xor_b32 v95, 0x80008000, v107
v_cos_f32 v48, v47
v_sin_f32 v49, v47
v_add_f32 v47, v47, v45
v_cos_f32 v64, v45
v_cos_f32 v50, v47
v_sin_f32 v51, v47
v_add_f32 v64, v64, v64
v_pk_fma_f32 v[52:53], v[50:51], v[64:65], v[48:49] op_sel_hi:[1,0,1] neg_lo:[0,0,1] neg_hi:[0,0,1]
v_pk_fma_f32 v[54:55], v[52:53], v[64:65], v[50:51] op_sel_hi:[1,0,1] neg_lo:[0,0,1] neg_hi:[0,0,1]
v_pk_fma_f32 v[56:57], v[54:55], v[64:65], v[52:53] op_sel_hi:[1,0,1] neg_lo:[0,0,1] neg_hi:[0,0,1]
v_pk_fma_f32 v[58:59], v[56:57], v[64:65], v[54:55] op_sel_hi:[1,0,1] neg_lo:[0,0,1] neg_hi:[0,0,1]
v_pk_fma_f32 v[60:61], v[58:59], v[64:65], v[56:57] op_sel_hi:[1,0,1] neg_lo:[0,0,1] neg_hi:[0,0,1]
v_pk_fma_f32 v[62:63], v[60:61], v[64:65], v[58:59] op_sel_hi:[1,0,1] neg_lo:[0,0,1] neg_hi:[0,0,1]
v_cvt_pk_bf16_f32 v96, v48, v50
v_cvt_pk_bf16_f32 v108, v49, v51
v_xor_b32 v100, 0x80008000, v108
v_cvt_pk_bf16_f32 v97, v52, v54
v_cvt_pk_bf16_f32 v109, v53, v55
v_xor_b32 v101, 0x80008000, v109
v_cvt_pk_bf16_f32 v98, v56, v58
v_cvt_pk_bf16_f32 v110, v57, v59
v_xor_b32 v102, 0x80008000, v110
v_cvt_pk_bf16_f32 v99, v60, v62
v_cvt_pk_bf16_f32 v111, v61, v63
v_xor_b32 v103, 0x80008000, v111
s_barrier
ds_read_b128 v[36:39], v157 offset:53248
ds_read_b128 v[40:43], v157 offset:54272
s_lshl_b32 s49, s3, 11
v_lshlrev_b32 v166, 4, v2
v_lshrrev_b32 v4, 2, v3
v_sub_u32 v4, 0, v4
v_and_b32 v4, 3, v4
v_xor_b32 v4, v4, v2
v_lshlrev_b32 v4, 4, v4
v_lshl_add_u32 v163, v3, 6, v4
v_add_u32 v163, s49, v163
s_lshl_b32 s49, s3, 7
s_add_u32 s49, s49, s2
s_lshl_b32 s49, s49, 7
s_add_u32 s49, s49, 131072
v_lshrrev_b32 v4, 1, v3
v_and_b32 v5, 1, v0
v_mul_u32_u24 v167, 0x28000, v4
v_lshl_add_u32 v167, v5, 6, v167
v_add3_u32 v167, v167, v166, s49
s_lshl_b32 s49, s3, 7
s_add_u32 s49, s49, 51904
v_lshl_add_u32 v155, v5, 5, s49
v_lshl_add_u32 v155, v4, 2, v155
v_lshrrev_b32 v4, 1, v2
v_and_b32 v154, 1, v2
v_lshl_add_u32 v154, v154, 2, v4
s_mul_i32 s49, s3, 72
v_lshl_add_u32 v154, v154, 3, s49
v_mul_u32_u24 v4, 720, v5
v_add_u32 v154, v154, v4
v_and_b32 v4, 0xff1, v0
v_cmp_eq_u32 vcc, 49, v4
v_mov_b32 v153, 0xffff
s_nop 0
v_cndmask_b32 v153, -1, v153, vcc
v_mov_b32 v120, 0
s_cmp_ge_u32 s3, 8
s_cbranch_scc1 L_a8b
s_and_b32 s62, s2, 7
s_lshr_b32 s56, s2, 4
s_mul_i32 s57, s62, 10
s_add_u32 s57, s57, s56
s_lshl_b32 s57, s57, 14
s_add_u32 s57, s57, 131072
v_lshl_add_u32 v112, v0, 4, s57
v_add_u32 v113, 0x2000, v112
v_lshlrev_b32 v6, 1, v0
v_and_b32 v6, 32, v6
v_and_b32 v7, 64, v0
v_or_b32 v6, v6, v7
v_lshlrev_b32 v7, 4, v0
v_xor_b32 v114, v6, v7
s_lshl_b32 s56, s56, 7
s_add_u32 s56, s56, 1441792
s_lshl_b32 s58, s3, 8
s_add_u32 s58, s58, s5
s_lshl2_add_u32 s59, s62, s58
s_mulk_i32 s59, 1280
s_add_u32 s59, s59, s56
s_lshl_b32 s60, s62, 2
s_add_u32 s60, s60, 995
s_sub_u32 s60, s60, s58
s_mulk_i32 s60, 1280
s_add_u32 s60, s60, s56
s_add_u32 s60, s60, 64
v_and_b32 v4, 7, v0
v_mul_u32_u24 v4, 40960, v4
v_lshrrev_b32 v5, 3, v3
v_lshl_add_u32 v4, v5, 6, v4
v_lshlrev_b32 v5, 4, v2
v_add3_u32 v120, v4, v5, s59
v_sub_u32 v121, s60, v4
v_add_u32 v121, v121, v5
v_lshrrev_b32 v5, 2, v3
v_lshl_add_u32 v4, v2, 3, v5
v_lshlrev_b32 v4, 7, v4
v_and_b32 v5, 3, v0
v_lshl_add_u32 v4, v5, 3, v4
v_bfe_u32 v5, v0, 3, 2
v_lshl_add_u32 v116, v5, 5, v4
v_xor_b32 v117, 64, v116
v_xor_b32 v118, 32, v116
v_xor_b32 v119, 96, v116
s_waitcnt vmcnt(0) lgkmcnt(0)
global_load_ushort v87, v87, s[28:29]
v_perm_b32 v20, v10, v8, s52
v_perm_b32 v21, v14, v12, s52
v_perm_b32 v22, v23, v16, s52
v_perm_b32 v24, v10, v8, s53
v_perm_b32 v25, v14, v12, s53
v_perm_b32 v26, v23, v16, s53
v_mfma_f32_16x16x32_bf16 v[44:47], v[36:39], v[20:23], 0
v_perm_b32 v28, v11, v9, s52
v_perm_b32 v29, v15, v13, s52
v_perm_b32 v30, v23, v17, s52
v_mfma_f32_16x16x32_bf16 v[48:51], v[36:39], v[24:27], 0
v_perm_b32 v32, v11, v9, s53
v_perm_b32 v33, v15, v13, s53
v_perm_b32 v34, v23, v17, s53
v_mfma_f32_16x16x32_bf16 v[52:55], v[36:39], v[28:31], 0
v_dot2c_f32_bf16 v18, v8, v8
v_dot2c_f32_bf16 v19, v9, v9
v_mfma_f32_16x16x32_bf16 v[56:59], v[36:39], v[32:35], 0
v_dot2c_f32_bf16 v18, v10, v10
v_dot2c_f32_bf16 v19, v11, v11
v_mfma_f32_16x16x32_bf16 v[60:63], v[40:43], v[20:23], 0
v_dot2c_f32_bf16 v18, v12, v12
v_dot2c_f32_bf16 v19, v13, v13
v_mfma_f32_16x16x32_bf16 v[64:67], v[40:43], v[24:27], 0
v_dot2c_f32_bf16 v18, v14, v14
v_dot2c_f32_bf16 v19, v15, v15
v_mfma_f32_16x16x32_bf16 v[68:71], v[40:43], v[28:31], 0
v_dot2c_f32_bf16 v18, v16, v16
v_dot2c_f32_bf16 v19, v17, v17
v_mfma_f32_16x16x32_bf16 v[72:75], v[40:43], v[32:35], 0
v_add_f32 v4, v47, v51
v_add_f32 v5, v55, v59
v_add_f32 v4, v4, v5
v_add_f32 v18, v18, v19
v_cvt_pk_bf16_f32 v78, v45, v49
v_add_f32_dpp v4, v4, v4 quad_perm:[1,0,3,2] row_mask:0xf bank_mask:0xf
v_add_f32_dpp v18, v18, v18 quad_perm:[1,0,3,2] row_mask:0xf bank_mask:0xf
v_cvt_pk_bf16_f32 v79, v53, v57
ds_write_b64 v160, v[78:79] offset:1024
v_cvt_pk_bf16_f32 v80, v46, v50
v_add_f32_dpp v4, v4, v4 quad_perm:[2,3,0,1] row_mask:0xf bank_mask:0xf
v_add_f32_dpp v18, v18, v18 quad_perm:[2,3,0,1] row_mask:0xf bank_mask:0xf
v_cvt_pk_bf16_f32 v81, v54, v58
ds_write_b64 v160, v[80:81] offset:2048
v_cvt_pk_bf16_f32 v82, v60, v64
v_add_f32_dpp v4, v4, v4 row_half_mirror row_mask:0xf bank_mask:0xf
v_add_f32_dpp v18, v18, v18 row_half_mirror row_mask:0xf bank_mask:0xf
v_cvt_pk_bf16_f32 v83, v68, v72
ds_write_b64 v160, v[82:83] offset:3072
v_cvt_pk_bf16_f32 v84, v61, v65
v_cvt_pk_bf16_f32 v85, v69, v73
ds_write_b64 v160, v[84:85] offset:4096
v_fmac_f32 v44, v4, v162
v_fmac_f32 v48, v4, v162
v_fmac_f32 v52, v4, v162
v_fmac_f32 v56, v4, v162
v_cvt_pk_bf16_f32 v76, v44, v48
v_cvt_pk_bf16_f32 v77, v52, v56
ds_write_b64 v160, v[76:77]
ds_write_b32 v86, v18 offset:22016
ds_write_b32 v161, v4 offset:21504
L_b1:
s_setprio 1
s_waitcnt lgkmcnt(0)
s_barrier
ds_read_b128 v[20:23], v163
ds_read_b128 v[28:31], v163 offset:1024
s_cmp_eq_u32 s3, 0
s_waitcnt lgkmcnt(1)
v_mfma_f32_16x16x32_bf16 v[44:47], v[20:23], v[88:91], 0
v_mfma_f32_16x16x32_bf16 v[48:51], v[20:23], v[92:95], 0
s_cbranch_scc1 L_u0
v_mfma_f32_16x16x32_bf16 v[52:55], v[20:23], v[96:99], 0
v_mfma_f32_16x16x32_bf16 v[56:59], v[20:23], v[100:103], 0
s_waitcnt lgkmcnt(0)
v_mfma_f32_16x16x32_bf16 v[44:47], v[28:31], v[104:107], v[44:47]
v_mfma_f32_16x16x32_bf16 v[48:51], v[28:31], v[88:91], v[48:51]
v_mfma_f32_16x16x32_bf16 v[52:55], v[28:31], v[108:111], v[52:55]
v_mfma_f32_16x16x32_bf16 v[56:59], v[28:31], v[96:99], v[56:59]
L_u1:
ds_read_b128 v[32:35], v157 offset:22528
s_waitcnt vmcnt(0)
ds_write_b16 v115, v87 offset:23552
s_nop 1
v_cvt_pk_bf16_f32 v20, v44, v45
v_cvt_pk_bf16_f32 v21, v46, v47
v_cvt_pk_bf16_f32 v22, v48, v49
v_cvt_pk_bf16_f32 v23, v50, v51
v_cvt_pk_bf16_f32 v24, v52, v53
v_cvt_pk_bf16_f32 v25, v54, v55
v_cvt_pk_bf16_f32 v26, v56, v57
v_cvt_pk_bf16_f32 v27, v58, v59
L_sm:
s_waitcnt lgkmcnt(0)
v_max3_u32 v4, v32, v33, v34
v_max_u32 v4, v4, v35
v_cmp_eq_u32 vcc, -1, v4
s_cbranch_vccnz L_smr
L_smd:
v_mfma_f32_16x16x32_bf16 v[44:47], v[20:23], v[32:35], 0
v_mfma_f32_16x16x32_bf16 v[48:51], v[24:27], v[32:35], 0
ds_read_b64 v[60:61], v154 offset:23552
ds_read_b64 v[62:63], v154 offset:23568
s_nop 4
v_cvt_pk_bf16_f32 v20, v44, v45
v_cvt_pk_bf16_f32 v21, v46, v47
v_cvt_pk_bf16_f32 v22, v48, v49
v_cvt_pk_bf16_f32 v23, v50, v51
global_store_dwordx4 v167, v[20:23], s[40:41] sc1
s_setprio 0
s_waitcnt lgkmcnt(0)
v_and_b32 v61, v61, v153
s_nop 1
v_mfma_f32_16x16x32_bf16 v[64:67], v[60:63], v[20:23], 0
s_nop 7
ds_write2_b32 v155, v64, v65 offset0:0 offset1:16
s_waitcnt lgkmcnt(0)
s_barrier
s_cmp_eq_u32 s3, 9
s_cbranch_scc1 L_ext
v_and_b32 v159, 7, v0
v_lshl_add_u32 v159, v2, 3, v159
v_mul_u32_u24 v159, 48, v159
ds_read_b128 v[144:147], v159 offset:25088
ds_read_b128 v[148:151], v159 offset:25104
ds_read_b64 v[152:153], v159 offset:25120
s_mul_i32 s51, s48, 1456
s_add_u32 s51, s51, 27136
v_lshrrev_b32 v156, 3, v3
v_mul_u32_u24 v156, 1456, v156
v_add_u32 v156, s51, v156
s_cmp_lt_u32 s3, 8
s_cbranch_scc1 L_scat
s_cmp_lg_u32 s2, 0
s_cbranch_scc1 L_fin
s_barrier
s_barrier
s_branch L_p2end
L_ext:
s_setprio 3
ds_read_b32 v44, v112 offset:51904
ds_read_b32 v45, v112 offset:52032
ds_read_b32 v46, v112 offset:52160
ds_read_b32 v47, v112 offset:52288
ds_read_b32 v48, v112 offset:52416
ds_read_b32 v49, v112 offset:52544
ds_read_b32 v50, v112 offset:52672
ds_read_b32 v51, v112 offset:52800
ds_read_b32 v52, v112 offset:52928
ds_read_b32 v53, v112 offset:53056
s_waitcnt lgkmcnt(0)
v_pk_add_f32 v[44:45], v[44:45], v[46:47]
v_pk_add_f32 v[48:49], v[48:49], v[50:51]
v_pk_add_f32 v[44:45], v[44:45], v[52:53]
v_pk_add_f32 v[44:45], v[44:45], v[48:49]
v_add_f32 v44, v44, v45
v_mul_f32 v44, v44, v113
v_mov_b32 v45, v44
s_nop 1
v_permlane32_swap_b32 v44, v45
v_add_f32 v44, v44, v45
v_mov_b32 v45, v44
s_nop 1
v_permlane16_swap_b32 v44, v45
v_add_f32 v44, v44, v45
s_nop 1
v_mov_b32_dpp v45, v44 quad_perm:[1,0,3,2] row_mask:0xf bank_mask:0xf
v_cvt_pk_bf16_f32 v44, v44, v45
s_mov_b64 exec, 0x5555
global_store_dword v120, v44, s[40:41] sc1
s_mov_b64 exec, -1
s_barrier
s_branch L_fin
L_scat:
s_cmp_ge_u32 s3, 4
s_cbranch_scc1 L_b2
s_waitcnt lgkmcnt(0)
v_add_u32_sdwa v4, v144, v156 dst_sel:DWORD dst_unused:UNUSED_PAD src0_sel:WORD_0 src1_sel:DWORD
v_add_u32_sdwa v5, v144, v156 dst_sel:DWORD dst_unused:UNUSED_PAD src0_sel:WORD_1 src1_sel:DWORD
ds_write_b16 v4, v8
ds_write_b16_d16_hi v5, v8
v_add_u32_sdwa v6, v145, v156 dst_sel:DWORD dst_unused:UNUSED_PAD src0_sel:WORD_0 src1_sel:DWORD
v_add_u32_sdwa v7, v145, v156 dst_sel:DWORD dst_unused:UNUSED_PAD src0_sel:WORD_1 src1_sel:DWORD
ds_write_b16 v6, v9
ds_write_b16_d16_hi v7, v9
v_add_u32_sdwa v4, v146, v156 dst_sel:DWORD dst_unused:UNUSED_PAD src0_sel:WORD_0 src1_sel:DWORD
v_add_u32_sdwa v5, v146, v156 dst_sel:DWORD dst_unused:UNUSED_PAD src0_sel:WORD_1 src1_sel:DWORD
ds_write_b16 v4, v10
ds_write_b16_d16_hi v5, v10
v_add_u32_sdwa v6, v147, v156 dst_sel:DWORD dst_unused:UNUSED_PAD src0_sel:WORD_0 src1_sel:DWORD
v_add_u32_sdwa v7, v147, v156 dst_sel:DWORD dst_unused:UNUSED_PAD src0_sel:WORD_1 src1_sel:DWORD
ds_write_b16 v6, v11
ds_write_b16_d16_hi v7, v11
v_add_u32_sdwa v4, v148, v156 dst_sel:DWORD dst_unused:UNUSED_PAD src0_sel:WORD_0 src1_sel:DWORD
v_add_u32_sdwa v5, v148, v156 dst_sel:DWORD dst_unused:UNUSED_PAD src0_sel:WORD_1 src1_sel:DWORD
ds_write_b16 v4, v12
ds_write_b16_d16_hi v5, v12
v_add_u32_sdwa v6, v149, v156 dst_sel:DWORD dst_unused:UNUSED_PAD src0_sel:WORD_0 src1_sel:DWORD
v_add_u32_sdwa v7, v149, v156 dst_sel:DWORD dst_unused:UNUSED_PAD src0_sel:WORD_1 src1_sel:DWORD
ds_write_b16 v6, v13
ds_write_b16_d16_hi v7, v13
v_add_u32_sdwa v4, v150, v156 dst_sel:DWORD dst_unused:UNUSED_PAD src0_sel:WORD_0 src1_sel:DWORD
v_add_u32_sdwa v5, v150, v156 dst_sel:DWORD dst_unused:UNUSED_PAD src0_sel:WORD_1 src1_sel:DWORD
ds_write_b16 v4, v14
ds_write_b16_d16_hi v5, v14
v_add_u32_sdwa v6, v151, v156 dst_sel:DWORD dst_unused:UNUSED_PAD src0_sel:WORD_0 src1_sel:DWORD
v_add_u32_sdwa v7, v151, v156 dst_sel:DWORD dst_unused:UNUSED_PAD src0_sel:WORD_1 src1_sel:DWORD
ds_write_b16 v6, v15
ds_write_b16_d16_hi v7, v15
v_add_u32_sdwa v4, v152, v156 dst_sel:DWORD dst_unused:UNUSED_PAD src0_sel:WORD_0 src1_sel:DWORD
v_add_u32_sdwa v5, v152, v156 dst_sel:DWORD dst_unused:UNUSED_PAD src0_sel:WORD_1 src1_sel:DWORD
ds_write_b16 v4, v16
ds_write_b16_d16_hi v5, v16
v_add_u32_sdwa v6, v153, v156 dst_sel:DWORD dst_unused:UNUSED_PAD src0_sel:WORD_0 src1_sel:DWORD
v_add_u32_sdwa v7, v153, v156 dst_sel:DWORD dst_unused:UNUSED_PAD src0_sel:WORD_1 src1_sel:DWORD
ds_write_b16 v6, v17
ds_write_b16_d16_hi v7, v17
L_b2:
s_waitcnt vmcnt(0) lgkmcnt(0)
s_barrier
global_load_dwordx4 v[40:43], v112, s[40:41] sc1
global_load_dwordx4 v[44:47], v113, s[40:41] sc1
s_cmp_ge_u32 s3, 4
s_cbranch_scc1 L_ntab
s_lshl3_add_u32 s56, s5, s3
s_lshl_b32 s56, s56, 4
s_add_u32 s56, s56, 1
v_and_b32 v16, 7, v0
v_lshl_add_u32 v16, v16, 1, s56
v_and_b32 v17, 8, v0
v_lshl_add_u32 v16, v17, 3, v16
v_cvt_f32_u32 v16, v16
v_lshlrev_b32 v17, 3, v2
v_cvt_f32_u32 v17, v17
v_mul_f32 v16, 0xbb000000, v16
v_cos_f32 v18, v16
v_mul_f32 v17, v17, v16
v_mul_f32 v20, 0x41f80000, v16
v_add_f32 v18, v18, v18
v_cos_f32 v24, v17
v_sin_f32 v25, v17
v_add_f32 v17, v17, v16
v_cos_f32 v26, v17
v_sin_f32 v27, v17
v_add_f32 v17, v17, v20
v_pk_fma_f32 v[28:29], v[26:27], v[18:19], v[24:25] op_sel_hi:[1,0,1] neg_lo:[0,0,1] neg_hi:[0,0,1]
v_pk_fma_f32 v[30:31], v[28:29], v[18:19], v[26:27] op_sel_hi:[1,0,1] neg_lo:[0,0,1] neg_hi:[0,0,1]
v_pk_fma_f32 v[32:33], v[30:31], v[18:19], v[28:29] op_sel_hi:[1,0,1] neg_lo:[0,0,1] neg_hi:[0,0,1]
v_pk_fma_f32 v[34:35], v[32:33], v[18:19], v[30:31] op_sel_hi:[1,0,1] neg_lo:[0,0,1] neg_hi:[0,0,1]
v_pk_fma_f32 v[36:37], v[34:35], v[18:19], v[32:33] op_sel_hi:[1,0,1] neg_lo:[0,0,1] neg_hi:[0,0,1]
v_pk_fma_f32 v[38:39], v[36:37], v[18:19], v[34:35] op_sel_hi:[1,0,1] neg_lo:[0,0,1] neg_hi:[0,0,1]
v_lshlrev_b32 v21, 31, v0
v_xor_b32 v21, -1.0, v21
v_cmp_eq_u32 vcc, 0, v2
s_nop 1
v_cndmask_b32 v25, v25, v21, vcc
v_cvt_pk_bf16_f32 v56, v24, v26
v_cvt_pk_bf16_f32 v72, v25, v27
v_cvt_pk_bf16_f32 v57, v28, v30
v_cvt_pk_bf16_f32 v73, v29, v31
v_cvt_pk_bf16_f32 v58, v32, v34
v_cvt_pk_bf16_f32 v74, v33, v35
v_cvt_pk_bf16_f32 v59, v36, v38
v_cvt_pk_bf16_f32 v75, v37, v39
v_cos_f32 v24, v17
v_sin_f32 v25, v17
v_add_f32 v17, v17, v16
v_cos_f32 v26, v17
v_sin_f32 v27, v17
v_add_f32 v17, v17, v20
v_pk_fma_f32 v[28:29], v[26:27], v[18:19], v[24:25] op_sel_hi:[1,0,1] neg_lo:[0,0,1] neg_hi:[0,0,1]
v_pk_fma_f32 v[30:31], v[28:29], v[18:19], v[26:27] op_sel_hi:[1,0,1] neg_lo:[0,0,1] neg_hi:[0,0,1]
v_pk_fma_f32 v[32:33], v[30:31], v[18:19], v[28:29] op_sel_hi:[1,0,1] neg_lo:[0,0,1] neg_hi:[0,0,1]
v_pk_fma_f32 v[34:35], v[32:33], v[18:19], v[30:31] op_sel_hi:[1,0,1] neg_lo:[0,0,1] neg_hi:[0,0,1]
v_pk_fma_f32 v[36:37], v[34:35], v[18:19], v[32:33] op_sel_hi:[1,0,1] neg_lo:[0,0,1] neg_hi:[0,0,1]
v_pk_fma_f32 v[38:39], v[36:37], v[18:19], v[34:35] op_sel_hi:[1,0,1] neg_lo:[0,0,1] neg_hi:[0,0,1]
v_cvt_pk_bf16_f32 v60, v24, v26
v_cvt_pk_bf16_f32 v76, v25, v27
v_cvt_pk_bf16_f32 v61, v28, v30
v_cvt_pk_bf16_f32 v77, v29, v31
v_cvt_pk_bf16_f32 v62, v32, v34
v_cvt_pk_bf16_f32 v78, v33, v35
v_cvt_pk_bf16_f32 v63, v36, v38
v_cvt_pk_bf16_f32 v79, v37, v39
v_cos_f32 v24, v17
v_sin_f32 v25, v17
v_add_f32 v17, v17, v16
v_cos_f32 v26, v17
v_sin_f32 v27, v17
v_add_f32 v17, v17, v20
v_pk_fma_f32 v[28:29], v[26:27], v[18:19], v[24:25] op_sel_hi:[1,0,1] neg_lo:[0,0,1] neg_hi:[0,0,1]
v_pk_fma_f32 v[30:31], v[28:29], v[18:19], v[26:27] op_sel_hi:[1,0,1] neg_lo:[0,0,1] neg_hi:[0,0,1]
v_pk_fma_f32 v[32:33], v[30:31], v[18:19], v[28:29] op_sel_hi:[1,0,1] neg_lo:[0,0,1] neg_hi:[0,0,1]
v_pk_fma_f32 v[34:35], v[32:33], v[18:19], v[30:31] op_sel_hi:[1,0,1] neg_lo:[0,0,1] neg_hi:[0,0,1]
v_pk_fma_f32 v[36:37], v[34:35], v[18:19], v[32:33] op_sel_hi:[1,0,1] neg_lo:[0,0,1] neg_hi:[0,0,1]
v_pk_fma_f32 v[38:39], v[36:37], v[18:19], v[34:35] op_sel_hi:[1,0,1] neg_lo:[0,0,1] neg_hi:[0,0,1]
v_cvt_pk_bf16_f32 v64, v24, v26
v_cvt_pk_bf16_f32 v80, v25, v27
v_cvt_pk_bf16_f32 v65, v28, v30
v_cvt_pk_bf16_f32 v81, v29, v31
v_cvt_pk_bf16_f32 v66, v32, v34
v_cvt_pk_bf16_f32 v82, v33, v35
v_cvt_pk_bf16_f32 v67, v36, v38
v_cvt_pk_bf16_f32 v83, v37, v39
v_cos_f32 v24, v17
v_sin_f32 v25, v17
v_add_f32 v17, v17, v16
v_cos_f32 v26, v17
v_sin_f32 v27, v17
v_add_f32 v17, v17, v20
v_pk_fma_f32 v[28:29], v[26:27], v[18:19], v[24:25] op_sel_hi:[1,0,1] neg_lo:[0,0,1] neg_hi:[0,0,1]
v_pk_fma_f32 v[30:31], v[28:29], v[18:19], v[26:27] op_sel_hi:[1,0,1] neg_lo:[0,0,1] neg_hi:[0,0,1]
v_pk_fma_f32 v[32:33], v[30:31], v[18:19], v[28:29] op_sel_hi:[1,0,1] neg_lo:[0,0,1] neg_hi:[0,0,1]
v_pk_fma_f32 v[34:35], v[32:33], v[18:19], v[30:31] op_sel_hi:[1,0,1] neg_lo:[0,0,1] neg_hi:[0,0,1]
v_pk_fma_f32 v[36:37], v[34:35], v[18:19], v[32:33] op_sel_hi:[1,0,1] neg_lo:[0,0,1] neg_hi:[0,0,1]
v_pk_fma_f32 v[38:39], v[36:37], v[18:19], v[34:35] op_sel_hi:[1,0,1] neg_lo:[0,0,1] neg_hi:[0,0,1]
v_cvt_pk_bf16_f32 v68, v24, v26
v_cvt_pk_bf16_f32 v84, v25, v27
v_cvt_pk_bf16_f32 v69, v28, v30
v_cvt_pk_bf16_f32 v85, v29, v31
v_cvt_pk_bf16_f32 v70, v32, v34
v_cvt_pk_bf16_f32 v86, v33, v35
v_cvt_pk_bf16_f32 v71, v36, v38
v_cvt_pk_bf16_f32 v87, v37, v39
s_branch L_ntab2
L_ntab:
s_cmp_ge_u32 s2, 128
s_cbranch_scc1 L_ntab2
v_add_u32_sdwa v4, v144, v156 dst_sel:DWORD dst_unused:UNUSED_PAD src0_sel:WORD_0 src1_sel:DWORD
v_add_u32_sdwa v5, v144, v156 dst_sel:DWORD dst_unused:UNUSED_PAD src0_sel:WORD_1 src1_sel:DWORD
ds_write_b16 v4, v8
ds_write_b16_d16_hi v5, v8
v_add_u32_sdwa v6, v145, v156 dst_sel:DWORD dst_unused:UNUSED_PAD src0_sel:WORD_0 src1_sel:DWORD
v_add_u32_sdwa v7, v145, v156 dst_sel:DWORD dst_unused:UNUSED_PAD src0_sel:WORD_1 src1_sel:DWORD
ds_write_b16 v6, v9
ds_write_b16_d16_hi v7, v9
v_add_u32_sdwa v4, v146, v156 dst_sel:DWORD dst_unused:UNUSED_PAD src0_sel:WORD_0 src1_sel:DWORD
v_add_u32_sdwa v5, v146, v156 dst_sel:DWORD dst_unused:UNUSED_PAD src0_sel:WORD_1 src1_sel:DWORD
ds_write_b16 v4, v10
ds_write_b16_d16_hi v5, v10
v_add_u32_sdwa v6, v147, v156 dst_sel:DWORD dst_unused:UNUSED_PAD src0_sel:WORD_0 src1_sel:DWORD
v_add_u32_sdwa v7, v147, v156 dst_sel:DWORD dst_unused:UNUSED_PAD src0_sel:WORD_1 src1_sel:DWORD
ds_write_b16 v6, v11
ds_write_b16_d16_hi v7, v11
v_add_u32_sdwa v4, v148, v156 dst_sel:DWORD dst_unused:UNUSED_PAD src0_sel:WORD_0 src1_sel:DWORD
v_add_u32_sdwa v5, v148, v156 dst_sel:DWORD dst_unused:UNUSED_PAD src0_sel:WORD_1 src1_sel:DWORD
ds_write_b16 v4, v12
ds_write_b16_d16_hi v5, v12
v_add_u32_sdwa v6, v149, v156 dst_sel:DWORD dst_unused:UNUSED_PAD src0_sel:WORD_0 src1_sel:DWORD
v_add_u32_sdwa v7, v149, v156 dst_sel:DWORD dst_unused:UNUSED_PAD src0_sel:WORD_1 src1_sel:DWORD
ds_write_b16 v6, v13
ds_write_b16_d16_hi v7, v13
v_add_u32_sdwa v4, v150, v156 dst_sel:DWORD dst_unused:UNUSED_PAD src0_sel:WORD_0 src1_sel:DWORD
v_add_u32_sdwa v5, v150, v156 dst_sel:DWORD dst_unused:UNUSED_PAD src0_sel:WORD_1 src1_sel:DWORD
ds_write_b16 v4, v14
ds_write_b16_d16_hi v5, v14
v_add_u32_sdwa v6, v151, v156 dst_sel:DWORD dst_unused:UNUSED_PAD src0_sel:WORD_0 src1_sel:DWORD
v_add_u32_sdwa v7, v151, v156 dst_sel:DWORD dst_unused:UNUSED_PAD src0_sel:WORD_1 src1_sel:DWORD
ds_write_b16 v6, v15
ds_write_b16_d16_hi v7, v15
v_add_u32_sdwa v4, v152, v156 dst_sel:DWORD dst_unused:UNUSED_PAD src0_sel:WORD_0 src1_sel:DWORD
v_add_u32_sdwa v5, v152, v156 dst_sel:DWORD dst_unused:UNUSED_PAD src0_sel:WORD_1 src1_sel:DWORD
ds_write_b16 v4, v16
ds_write_b16_d16_hi v5, v16
v_add_u32_sdwa v6, v153, v156 dst_sel:DWORD dst_unused:UNUSED_PAD src0_sel:WORD_0 src1_sel:DWORD
v_add_u32_sdwa v7, v153, v156 dst_sel:DWORD dst_unused:UNUSED_PAD src0_sel:WORD_1 src1_sel:DWORD
ds_write_b16 v6, v17
ds_write_b16_d16_hi v7, v17
L_ntab2:
LW0:
s_waitcnt vmcnt(0)
LV0:
v_max_u32 v16, v40, v41
v_max3_u32 v16, v16, v42, v43
v_max3_u32 v16, v16, v44, v45
v_max3_u32 v16, v16, v46, v47
v_cmp_eq_u32 vcc, -1, v16
s_cbranch_vccnz LR0
LD0:
s_mov_b64 exec, -1
ds_write_b128 v114, v[40:43] offset:0
ds_write_b128 v114, v[44:47] offset:8192
s_waitcnt lgkmcnt(0)
s_barrier
s_cmp_ge_u32 s3, 4
s_cbranch_scc1 L_p2end
s_setprio 2
ds_read_b64_tr_b16 v[8:9], v116 offset:0
ds_read_b64_tr_b16 v[10:11], v116 offset:512
ds_read_b64_tr_b16 v[12:13], v117 offset:0
ds_read_b64_tr_b16 v[14:15], v117 offset:512
ds_read_b64_tr_b16 v[16:17], v118 offset:0
ds_read_b64_tr_b16 v[18:19], v118 offset:512
ds_read_b64_tr_b16 v[20:21], v119 offset:0
ds_read_b64_tr_b16 v[22:23], v119 offset:512
ds_read_b64_tr_b16 v[24:25], v116 offset:4096
ds_read_b64_tr_b16 v[26:27], v116 offset:4608
ds_read_b64_tr_b16 v[28:29], v117 offset:4096
ds_read_b64_tr_b16 v[30:31], v117 offset:4608
ds_read_b64_tr_b16 v[32:33], v118 offset:4096
ds_read_b64_tr_b16 v[34:35], v118 offset:4608
s_waitcnt lgkmcnt(12)
v_mfma_f32_16x16x32_bf16 v[40:43], v[8:11], v[56:59], 0
ds_read_b64_tr_b16 v[36:37], v119 offset:4096
ds_read_b64_tr_b16 v[38:39], v119 offset:4608
s_waitcnt lgkmcnt(12)
v_mfma_f32_16x16x32_bf16 v[44:47], v[12:15], v[72:75], 0
ds_read_b64_tr_b16 v[8:9], v116 offset:8192
ds_read_b64_tr_b16 v[10:11], v116 offset:8704
s_waitcnt lgkmcnt(12)
v_mfma_f32_16x16x32_bf16 v[48:51], v[16:19], v[56:59], 0
ds_read_b64_tr_b16 v[12:13], v117 offset:8192
ds_read_b64_tr_b16 v[14:15], v117 offset:8704
s_waitcnt lgkmcnt(12)
v_mfma_f32_16x16x32_bf16 v[52:55], v[20:23], v[72:75], 0
ds_read_b64_tr_b16 v[16:17], v118 offset:8192
ds_read_b64_tr_b16 v[18:19], v118 offset:8704
s_waitcnt lgkmcnt(12)
v_mfma_f32_16x16x32_bf16 v[40:43], v[24:27], v[60:63], v[40:43]
ds_read_b64_tr_b16 v[20:21], v119 offset:8192
ds_read_b64_tr_b16 v[22:23], v119 offset:8704
s_waitcnt lgkmcnt(12)
v_mfma_f32_16x16x32_bf16 v[44:47], v[28:31], v[76:79], v[44:47]
ds_read_b64_tr_b16 v[24:25], v116 offset:12288
ds_read_b64_tr_b16 v[26:27], v116 offset:12800
s_waitcnt lgkmcnt(12)
v_mfma_f32_16x16x32_bf16 v[48:51], v[32:35], v[60:63], v[48:51]
ds_read_b64_tr_b16 v[28:29], v117 offset:12288
ds_read_b64_tr_b16 v[30:31], v117 offset:12800
s_waitcnt lgkmcnt(12)
v_mfma_f32_16x16x32_bf16 v[52:55], v[36:39], v[76:79], v[52:55]
ds_read_b64_tr_b16 v[32:33], v118 offset:12288
ds_read_b64_tr_b16 v[34:35], v118 offset:12800
s_waitcnt lgkmcnt(12)
v_mfma_f32_16x16x32_bf16 v[40:43], v[8:11], v[64:67], v[40:43]
ds_read_b64_tr_b16 v[36:37], v119 offset:12288
ds_read_b64_tr_b16 v[38:39], v119 offset:12800
s_waitcnt lgkmcnt(12)
v_mfma_f32_16x16x32_bf16 v[44:47], v[12:15], v[80:83], v[44:47]
s_waitcnt lgkmcnt(10)
v_mfma_f32_16x16x32_bf16 v[48:51], v[16:19], v[64:67], v[48:51]
s_waitcnt lgkmcnt(8)
v_mfma_f32_16x16x32_bf16 v[52:55], v[20:23], v[80:83], v[52:55]
s_waitcnt lgkmcnt(6)
v_mfma_f32_16x16x32_bf16 v[40:43], v[24:27], v[68:71], v[40:43]
s_waitcnt lgkmcnt(4)
v_mfma_f32_16x16x32_bf16 v[44:47], v[28:31], v[84:87], v[44:47]
s_waitcnt lgkmcnt(2)
v_mfma_f32_16x16x32_bf16 v[48:51], v[32:35], v[68:71], v[48:51]
s_waitcnt lgkmcnt(0)
v_mfma_f32_16x16x32_bf16 v[52:55], v[36:39], v[84:87], v[52:55]
s_nop 3
v_pk_add_f32 v[8:9], v[40:41], v[44:45] neg_lo:[0,1] neg_hi:[0,1]
v_pk_add_f32 v[10:11], v[42:43], v[46:47] neg_lo:[0,1] neg_hi:[0,1]
v_pk_add_f32 v[16:17], v[40:41], v[44:45]
v_pk_add_f32 v[18:19], v[42:43], v[46:47]
v_cvt_pk_bf16_f32 v24, v8, v9
v_cvt_pk_bf16_f32 v25, v10, v11
v_cvt_pk_bf16_f32 v28, v16, v17
v_cvt_pk_bf16_f32 v29, v18, v19
v_pk_add_f32 v[12:13], v[48:49], v[52:53] neg_lo:[0,1] neg_hi:[0,1]
v_pk_add_f32 v[14:15], v[50:51], v[54:55] neg_lo:[0,1] neg_hi:[0,1]
v_cvt_pk_bf16_f32 v26, v12, v13
v_cvt_pk_bf16_f32 v27, v14, v15
global_store_dwordx4 v120, v[24:27], s[40:41] sc1
v_pk_add_f32 v[20:21], v[48:49], v[52:53]
v_pk_add_f32 v[22:23], v[50:51], v[54:55]
v_cvt_pk_bf16_f32 v30, v20, v21
v_cvt_pk_bf16_f32 v31, v22, v23
global_store_dwordx4 v121, v[28:31], s[40:41] sc1
s_setprio 0
L_p2end:
s_cmp_ge_u32 s2, 128
s_cbranch_scc1 L_fin
s_movk_i32 s62, 72
v_lshrrev_b32 v4, 3, v1
v_and_b32 v5, 7, v0
v_lshlrev_b32 v5, 3, v5
v_mad_u32_u24 v122, v4, s62, v5
v_lshl_add_u32 v128, v4, 7, v5
v_lshlrev_b32 v5, 2, v3
v_mad_u32_u24 v123, v2, s62, v5
v_lshl_add_u32 v130, v2, 7, v5
v_cmp_eq_u32 vcc, 0, v2
v_add_u32 v124, 1296, v122
v_subrev_u32 v4, 144, v122
v_cndmask_b32 v124, v4, v124, vcc
v_add_u32 v125, s51, v122
v_add_u32 v126, s51, v123
v_add_u32 v127, s51, v124
ds_read_b64 v[88:89], v125
ds_read_b64 v[90:91], v125 offset:576
ds_read_b32 v92, v126 offset:1152
ds_read_b64 v[94:95], v125 offset:2176
ds_read_b64 v[96:97], v127 offset:1456
ds_read_b32 v93, v126 offset:1888
ds_read_b64 v[98:99], v122 offset:23552
ds_read_b64 v[100:101], v122 offset:24128
ds_read_b32 v102, v123 offset:24704
ds_read_b64 v[104:105], v122 offset:24272
ds_read_b64 v[106:107], v124 offset:23552
ds_read_b32 v103, v123 offset:23984
v_cmp_eq_u32 vcc, 0, v2
v_lshlrev_b32 v138, 3, v1
v_add_u32 v139, 512, v138
v_lshlrev_b32 v140, 2, v1
v_add_u32 v143, 384, v140
v_add_u32 v140, 1024, v140
v_add_u32 v141, 640, v138
v_add_u32 v142, 1152, v138
v_subrev_u32 v4, 128, v138
v_cndmask_b32 v142, v4, v142, vcc
s_and_b32 s56, s46, 255
s_lshr_b32 s59, s46, 9
s_lshl2_add_u32 s56, s56, s59
s_mulk_i32 s56, 1280
s_bfe_u32 s59, s46, 0x10008
s_lshl_b32 s59, s59, 6
s_add_u32 s56, s56, s59
s_add_u32 s56, s56, 1441792
s_sub_u32 s58, 2048, s46
s_and_b32 s58, s58, 2047
s_and_b32 s57, s58, 255
s_lshr_b32 s59, s58, 9
s_lshl2_add_u32 s57, s57, s59
s_mulk_i32 s57, 1280
s_bfe_u32 s59, s58, 0x10008
s_lshl_b32 s59, s59, 6
s_add_u32 s57, s57, s59
s_add_u32 s57, s57, 1441792
s_add_u32 s62, s56, 1024
s_sub_u32 s59, s57, 256
v_mov_b32 v129, s59
v_mov_b32 v4, s62
v_cndmask_b32 v129, v129, v4, vcc
v_add_u32 v129, v129, v128
v_add_u32 v128, s56, v128
s_add_u32 s62, s57, 768
v_add_u32 v130, s62, v130
v_cmp_eq_u32 vcc, 21, v1
v_mov_b32 v132, 0xffff
v_lshlrev_b32 v137, 4, v3
v_cndmask_b32 v131, -1, v132, vcc
v_cmp_eq_u32 vcc, 5, v1
s_lshl_b32 s57, s2, 4
v_add_u32 v135, s57, v3
v_cndmask_b32 v132, -1, v132, vcc
s_lshl_b32 s57, s48, 4
v_lshl_add_u32 v133, v2, 2, s57
s_add_u32 s57, s57, 16
s_cmp_eq_u32 s50, 0
s_cselect_b32 s57, 272, s57
v_lshl_add_u32 v134, v2, 2, s57
s_mov_b32 s63, 0x3f803f80
v_lshlrev_b32 v136, 2, v135
v_add_u32 v136, 2752512, v136
v_mov_b32 v108, 0
v_mov_b32 v109, 0
v_mov_b32 v110, 0
v_mov_b32 v111, 0
v_mov_b32 v160, 0
v_mov_b32 v161, 0
v_mov_b32 v162, 0
v_mov_b32 v163, 0
v_mov_b32 v164, 0
v_mov_b32 v165, 0
v_mov_b32 v166, 0
v_mov_b32 v167, 0
s_and_b32 s60, s2, 7
s_lshl_b32 s60, s60, 7
s_add_u32 s60, s60, 2814976
v_lshl_add_u32 v19, v3, 2, s60
v_lshlrev_b32 v155, 7, v1
v_add_u32 v155, 2940928, v155
v_add_u32 v121, 0x2000, v155
s_waitcnt vmcnt(0)
s_barrier
global_load_dword v71, v19, s[40:41] sc1
global_load_dwordx2 v[112:113], v128, s[40:41] sc1
global_load_dwordx2 v[114:115], v129, s[40:41] sc1
global_load_dword v116, v130, s[40:41] sc1
s_waitcnt lgkmcnt(0)
v_dot2c_f32_bf16 v108, s63, v88
v_dot2c_f32_bf16 v109, v88, v98
v_dot2c_f32_bf16 v110, v88, v88
v_dot2c_f32_bf16 v111, s63, v98
v_dot2c_f32_bf16 v160, s63, v94
v_dot2c_f32_bf16 v161, v94, v104
v_dot2c_f32_bf16 v162, v94, v94
v_dot2c_f32_bf16 v108, s63, v89
v_dot2c_f32_bf16 v109, v89, v99
v_dot2c_f32_bf16 v110, v89, v89
v_dot2c_f32_bf16 v111, s63, v99
v_dot2c_f32_bf16 v160, s63, v95
v_dot2c_f32_bf16 v161, v95, v105
v_dot2c_f32_bf16 v162, v95, v95
v_dot2c_f32_bf16 v108, s63, v90
v_dot2c_f32_bf16 v109, v90, v100
v_dot2c_f32_bf16 v110, v90, v90
v_dot2c_f32_bf16 v111, s63, v100
v_dot2c_f32_bf16 v160, s63, v96
v_dot2c_f32_bf16 v161, v96, v106
v_dot2c_f32_bf16 v162, v96, v96
v_dot2c_f32_bf16 v108, s63, v91
v_dot2c_f32_bf16 v109, v91, v101
v_dot2c_f32_bf16 v110, v91, v91
v_dot2c_f32_bf16 v111, s63, v101
v_dot2c_f32_bf16 v160, s63, v97
v_dot2c_f32_bf16 v161, v97, v107
v_dot2c_f32_bf16 v162, v97, v97
v_dot2c_f32_bf16 v108, s63, v92
v_dot2c_f32_bf16 v109, v92, v102
v_dot2c_f32_bf16 v110, v92, v92
v_dot2c_f32_bf16 v111, s63, v102
v_dot2c_f32_bf16 v160, s63, v93
v_dot2c_f32_bf16 v161, v93, v103
v_dot2c_f32_bf16 v162, v93, v93
v_mov_b32 v163, v111
v_mov_b32 v18, 0x3727c5ac
s_mov_b32 s58, 0x3acccccd
s_movk_i32 s59, 0x7ff
v_lshlrev_b32 v32, 16, v88
v_and_b32 v33, 0xffff0000, v88
v_lshlrev_b32 v34, 16, v89
v_and_b32 v35, 0xffff0000, v89
v_lshlrev_b32 v36, 16, v90
v_and_b32 v37, 0xffff0000, v90
v_lshlrev_b32 v38, 16, v91
v_and_b32 v39, 0xffff0000, v91
v_lshlrev_b32 v40, 16, v92
v_and_b32 v41, 0xffff0000, v92
v_lshlrev_b32 v42, 16, v94
v_and_b32 v43, 0xffff0000, v94
v_lshlrev_b32 v44, 16, v95
v_and_b32 v45, 0xffff0000, v95
v_lshlrev_b32 v46, 16, v96
v_and_b32 v47, 0xffff0000, v96
v_lshlrev_b32 v48, 16, v97
v_and_b32 v49, 0xffff0000, v97
v_lshlrev_b32 v50, 16, v93
v_and_b32 v51, 0xffff0000, v93
v_lshlrev_b32 v154, 4, v0
v_and_b32 v154, 0x1fff, v154
v_add_u32 v154, 2752512, v154
v_mov_b32 v119, 21952
s_mov_b32 s61, 0
s_mov_b32 s62, 0
s_movk_i32 s44, 99
s_movk_i32 s45, 99
s_cmp_lt_u32 s3, 8
s_cselect_b64 s[56:57], 1, 0
s_add_u32 s49, s48, 1
s_waitcnt vmcnt(3)
v_cmp_eq_u32 vcc, -1, v71
s_mov_b32 s55, 1
s_mov_b32 s54, -1
s_cbranch_vccnz L_l2
s_mov_b32 s55, 0
v_cmp_eq_u32_e64 s[24:25], s46, v71
v_cmp_eq_u32_e64 s[26:27], s47, v71
s_ff1_i32_b64 s52, s[24:25]
s_ff1_i32_b64 s53, s[26:27]
s_cmp_eq_u32 s50, 0
s_cselect_b32 s53, -1, s53
s_and_b32 s54, s52, s53
s_cmp_lt_i32 s54, 0
s_cbranch_scc1 L_nl
s_cmp_eq_u32 s50, 0
s_cselect_b32 s26, 0, s26
s_or_b32 exec_lo, s24, s26
s_mov_b32 exec_hi, exec_lo
global_store_dword v155, v155, s[40:41] sc1
global_store_dword v121, v155, s[40:41] sc1
s_mov_b64 exec, -1
s_waitcnt vmcnt(2)
s_branch LV1
L_nl:
LW1:
s_waitcnt vmcnt(0)
LV1:
v_max3_u32 v4, v112, v113, v114
v_max3_u32 v4, v4, v115, v116
v_cmp_eq_u32 vcc, -1, v4
s_cbranch_vccnz LR1
LD1:
s_mov_b64 exec, -1
v_and_b32 v117, v115, v131
v_and_b32 v118, v113, v132
s_cmp_lg_u32 s55, 0
s_cbranch_scc1 L_l3
s_cmp_lt_i32 s54, 0
s_cbranch_scc0 L_cand
L_nc:
v_dot2c_f32_bf16 v164, s63, v112
v_dot2c_f32_bf16 v165, v112, v112
v_dot2c_f32_bf16 v166, v112, v88
v_dot2c_f32_bf16 v167, v112, v94
v_dot2c_f32_bf16 v109, v112, v98
v_dot2c_f32_bf16 v161, v112, v104
v_dot2c_f32_bf16 v164, s63, v114
v_dot2c_f32_bf16 v165, v114, v114
v_dot2c_f32_bf16 v166, v114, v90
v_dot2c_f32_bf16 v167, v114, v96
v_dot2c_f32_bf16 v109, v114, v100
v_dot2c_f32_bf16 v161, v114, v106
v_dot2c_f32_bf16 v164, s63, v116
v_dot2c_f32_bf16 v165, v116, v116
v_dot2c_f32_bf16 v166, v116, v92
v_dot2c_f32_bf16 v167, v116, v93
v_dot2c_f32_bf16 v109, v116, v102
v_dot2c_f32_bf16 v161, v116, v103
v_dot2c_f32_bf16 v164, s63, v113
v_dot2c_f32_bf16 v165, v113, v113
v_dot2c_f32_bf16 v166, v113, v89
v_dot2c_f32_bf16 v167, v118, v95
v_dot2c_f32_bf16 v109, v113, v99
v_dot2c_f32_bf16 v161, v118, v105
v_dot2c_f32_bf16 v164, s63, v117
v_dot2c_f32_bf16 v165, v117, v117
v_dot2c_f32_bf16 v166, v117, v91
v_dot2c_f32_bf16 v167, v115, v97
v_dot2c_f32_bf16 v109, v117, v101
v_dot2c_f32_bf16 v161, v115, v107
v_add_f32 v108, v108, v164
v_add_f32 v160, v160, v164
v_add_f32 v110, v110, v165
v_add_f32 v162, v162, v165
v_fmac_f32 v110, 2.0, v166
v_fmac_f32 v162, 2.0, v167
v_permlane32_swap_b32 v108, v109
v_permlane32_swap_b32 v160, v161
v_permlane32_swap_b32 v110, v111
v_permlane32_swap_b32 v162, v163
v_add_f32 v108, v108, v109
v_add_f32 v110, v110, v111
v_add_f32 v160, v160, v161
v_add_f32 v162, v162, v163
v_permlane16_swap_b32 v108, v110
s_nop 0
v_permlane16_swap_b32 v160, v162
v_add_f32 v108, v108, v110
v_add_f32 v160, v160, v162
s_nop 0
v_add_f32_dpp v108, v108, v108 row_ror:8 row_mask:0xf bank_mask:0xf
v_add_f32_dpp v160, v160, v160 row_ror:8 row_mask:0xf bank_mask:0xf
s_nop 0
v_add_f32_dpp v108, v108, v108 row_ror:4 row_mask:0xf bank_mask:0xf
v_add_f32_dpp v160, v160, v160 row_ror:4 row_mask:0xf bank_mask:0xf
s_nop 0
v_add_f32_dpp v108, v108, v108 row_ror:2 row_mask:0xf bank_mask:0xf
v_add_f32_dpp v160, v160, v160 row_ror:2 row_mask:0xf bank_mask:0xf
s_nop 0
v_add_f32_dpp v108, v108, v108 row_ror:1 row_mask:0xf bank_mask:0xf
v_add_f32_dpp v160, v160, v160 row_ror:1 row_mask:0xf bank_mask:0xf
ds_write_b32 v133, v108 offset:21632
ds_write_b32 v134, v160 offset:21632
s_cmp_lt_i32 s54, 0
s_cbranch_scc0 L_cst
L_nc1:
s_waitcnt lgkmcnt(0)
s_barrier
ds_read_b128 v[76:79], v137 offset:21632
s_waitcnt lgkmcnt(0)
v_mul_f32 v76, s58, v76
v_fma_f32 v77, v77, s58, v18
v_fma_f32 v77, -v76, v76, v77
v_max_f32 v77, v77, v18
v_rsq_f32 v77, v77
v_fma_f32 v78, -v76, v79, v78
v_mul_f32 v78, v78, v77
v_ashrrev_i32 v79, 31, v78
v_or_b32 v79, 0x80000000, v79
v_xor_b32 v79, v79, v78
v_bfi_b32 v79, s59, v135, v79
v_min_u32 v79, -2, v79
s_cmp_lg_u32 s3, 0
s_cbranch_scc1 L_nokey
s_mov_b64 exec, 0xffff
global_store_dword v136, v79, s[40:41] sc1
s_mov_b64 exec, -1
L_nokey:
v_mul_f32 v76, v76, v77
v_readlane_b32 s8, v77, s48
v_readlane_b32 s12, v77, s49
v_readlane_b32 s10, v76, s48
v_readlane_b32 s18, v76, s49
v_readlane_b32 s20, v79, s48
v_readlane_b32 s21, v79, s49
v_readlane_b32 s22, v78, s48
v_readlane_b32 s23, v78, s49
s_cmp_eq_u32 s50, 0
s_cselect_b32 s21, 0, s21
v_mov_b32 v80, s10
v_mov_b32 v82, s18
s_cmp_eq_u32 s55, 0
s_cbranch_scc1 L_nc2
global_load_dword v71, v19, s[40:41] sc1
LW2:
s_waitcnt vmcnt(0)
LV2:
v_cmp_eq_u32 vcc, -1, v71
s_cbranch_vccnz LR2
LD2:
s_mov_b64 exec, -1
v_cmp_eq_u32_e64 s[24:25], s46, v71
v_cmp_eq_u32_e64 s[26:27], s47, v71
s_ff1_i32_b64 s52, s[24:25]
s_ff1_i32_b64 s53, s[26:27]
s_cmp_eq_u32 s50, 0
s_cselect_b32 s53, -1, s53
s_and_b32 s54, s52, s53
s_cmp_lt_i32 s54, 0
s_cbranch_scc1 L_nc2
s_cmp_eq_u32 s50, 0
s_cselect_b32 s26, 0, s26
s_or_b32 exec_lo, s24, s26
s_mov_b32 exec_hi, exec_lo
global_store_dword v155, v155, s[40:41] sc1
global_store_dword v121, v155, s[40:41] sc1
s_mov_b64 exec, -1
s_branch L_cand
L_nc2:
s_cmp_lt_i32 s52, 0
s_cbranch_scc0 L_na
v_lshlrev_b32 v4, 16, v112
v_and_b32 v5, 0xffff0000, v112
v_pk_add_f32 v[32:33], v[32:33], v[4:5]
v_cvt_pk_bf16_f32 v60, v32, v33
v_lshlrev_b32 v4, 16, v113
v_and_b32 v5, 0xffff0000, v113
v_pk_add_f32 v[34:35], v[34:35], v[4:5]
v_cvt_pk_bf16_f32 v61, v34, v35
v_lshlrev_b32 v4, 16, v114
v_and_b32 v5, 0xffff0000, v114
v_pk_add_f32 v[36:37], v[36:37], v[4:5]
v_cvt_pk_bf16_f32 v62, v36, v37
v_lshlrev_b32 v4, 16, v117
v_and_b32 v5, 0xffff0000, v117
v_pk_add_f32 v[38:39], v[38:39], v[4:5]
v_cvt_pk_bf16_f32 v63, v38, v39
v_lshlrev_b32 v4, 16, v116
v_and_b32 v5, 0xffff0000, v116
v_pk_add_f32 v[40:41], v[40:41], v[4:5]
v_cvt_pk_bf16_f32 v64, v40, v41
L_na:
s_cmp_lt_i32 s53, 0
s_cbranch_scc0 L_nb2
v_lshlrev_b32 v4, 16, v112
v_and_b32 v5, 0xffff0000, v112
v_pk_add_f32 v[42:43], v[42:43], v[4:5]
v_cvt_pk_bf16_f32 v66, v42, v43
v_lshlrev_b32 v4, 16, v118
v_and_b32 v5, 0xffff0000, v118
v_pk_add_f32 v[44:45], v[44:45], v[4:5]
v_cvt_pk_bf16_f32 v67, v44, v45
v_lshlrev_b32 v4, 16, v114
v_and_b32 v5, 0xffff0000, v114
v_pk_add_f32 v[46:47], v[46:47], v[4:5]
v_cvt_pk_bf16_f32 v68, v46, v47
v_lshlrev_b32 v4, 16, v115
v_and_b32 v5, 0xffff0000, v115
v_pk_add_f32 v[48:49], v[48:49], v[4:5]
v_cvt_pk_bf16_f32 v69, v48, v49
v_lshlrev_b32 v4, 16, v116
v_and_b32 v5, 0xffff0000, v116
v_pk_add_f32 v[50:51], v[50:51], v[4:5]
v_cvt_pk_bf16_f32 v70, v50, v51
L_nb2:
v_pk_fma_f32 v[8:9], v[32:33], s[8:9], v[80:81] op_sel_hi:[1,0,0] neg_lo:[0,0,1] neg_hi:[0,0,1]
v_pk_fma_f32 v[10:11], v[34:35], s[8:9], v[80:81] op_sel_hi:[1,0,0] neg_lo:[0,0,1] neg_hi:[0,0,1]
v_pk_fma_f32 v[12:13], v[36:37], s[8:9], v[80:81] op_sel_hi:[1,0,0] neg_lo:[0,0,1] neg_hi:[0,0,1]
v_pk_fma_f32 v[14:15], v[38:39], s[8:9], v[80:81] op_sel_hi:[1,0,0] neg_lo:[0,0,1] neg_hi:[0,0,1]
v_pk_fma_f32 v[16:17], v[40:41], s[8:9], v[80:81] op_sel_hi:[1,0,0] neg_lo:[0,0,1] neg_hi:[0,0,1]
v_pk_fma_f32 v[20:21], v[42:43], s[12:13], v[82:83] op_sel_hi:[1,0,0] neg_lo:[0,0,1] neg_hi:[0,0,1]
v_pk_fma_f32 v[22:23], v[44:45], s[12:13], v[82:83] op_sel_hi:[1,0,0] neg_lo:[0,0,1] neg_hi:[0,0,1]
v_pk_fma_f32 v[24:25], v[46:47], s[12:13], v[82:83] op_sel_hi:[1,0,0] neg_lo:[0,0,1] neg_hi:[0,0,1]
v_pk_fma_f32 v[26:27], v[48:49], s[12:13], v[82:83] op_sel_hi:[1,0,0] neg_lo:[0,0,1] neg_hi:[0,0,1]
v_pk_fma_f32 v[28:29], v[50:51], s[12:13], v[82:83] op_sel_hi:[1,0,0] neg_lo:[0,0,1] neg_hi:[0,0,1]
v_mov_b32 v4, v79
s_nop 1
v_max_u32_dpp v4, v4, v4 row_ror:8 row_mask:0xf bank_mask:0xf
s_nop 1
v_max_u32_dpp v4, v4, v4 row_ror:4 row_mask:0xf bank_mask:0xf
s_nop 1
v_max_u32_dpp v4, v4, v4 row_ror:2 row_mask:0xf bank_mask:0xf
s_nop 1
v_max_u32_dpp v4, v4, v4 row_ror:1 row_mask:0xf bank_mask:0xf
v_cmp_ne_u32 vcc, v4, v79
v_readfirstlane_b32 s6, v4
s_nop 0
v_cndmask_b32 v79, 0, v79, vcc
v_mov_b32 v4, v79
s_nop 1
v_max_u32_dpp v4, v4, v4 row_ror:8 row_mask:0xf bank_mask:0xf
s_nop 1
v_max_u32_dpp v4, v4, v4 row_ror:4 row_mask:0xf bank_mask:0xf
s_nop 1
v_max_u32_dpp v4, v4, v4 row_ror:2 row_mask:0xf bank_mask:0xf
s_nop 1
v_max_u32_dpp v4, v4, v4 row_ror:1 row_mask:0xf bank_mask:0xf
v_cmp_ne_u32 vcc, v4, v79
v_readfirstlane_b32 s7, v4
s_nop 0
v_cndmask_b32 v79, 0, v79, vcc
v_pk_add_f32 v[4:5], v[32:33], v[8:9]
v_cvt_pk_bf16_f32 v88, v4, v5
v_pk_add_f32 v[4:5], v[34:35], v[10:11]
v_cvt_pk_bf16_f32 v89, v4, v5
v_pk_add_f32 v[4:5], v[36:37], v[12:13]
v_cvt_pk_bf16_f32 v90, v4, v5
v_pk_add_f32 v[4:5], v[38:39], v[14:15]
v_cvt_pk_bf16_f32 v91, v4, v5
v_pk_add_f32 v[4:5], v[40:41], v[16:17]
v_cvt_pk_bf16_f32 v92, v4, v5
v_pk_add_f32 v[4:5], v[42:43], v[20:21]
v_cvt_pk_bf16_f32 v94, v4, v5
v_pk_add_f32 v[4:5], v[44:45], v[22:23]
v_cvt_pk_bf16_f32 v95, v4, v5
v_pk_add_f32 v[4:5], v[46:47], v[24:25]
v_cvt_pk_bf16_f32 v96, v4, v5
v_pk_add_f32 v[4:5], v[48:49], v[26:27]
v_cvt_pk_bf16_f32 v97, v4, v5
v_pk_add_f32 v[4:5], v[50:51], v[28:29]
v_cvt_pk_bf16_f32 v98, v4, v5
ds_write_b64 v125, v[88:89]
ds_write_b64 v125, v[90:91] offset:576
ds_write_b32 v126, v92 offset:1152
s_cmp_eq_u32 s50, 0
s_cbranch_scc1 L_nob
ds_write_b64 v125, v[94:95] offset:2176
ds_write_b64 v127, v[96:97] offset:1456
ds_write_b32 v126, v98 offset:1888
L_nob:
global_load_dwordx4 v[72:75], v154, s[40:41] sc1
v_add_u32_sdwa v4, v144, v156 dst_sel:DWORD dst_unused:UNUSED_PAD src0_sel:WORD_0 src1_sel:DWORD
v_add_u32_sdwa v5, v144, v156 dst_sel:DWORD dst_unused:UNUSED_PAD src0_sel:WORD_1 src1_sel:DWORD
ds_read_u16 v8, v4
ds_read_u16 v20, v5
v_add_u32_sdwa v6, v145, v156 dst_sel:DWORD dst_unused:UNUSED_PAD src0_sel:WORD_0 src1_sel:DWORD
v_add_u32_sdwa v7, v145, v156 dst_sel:DWORD dst_unused:UNUSED_PAD src0_sel:WORD_1 src1_sel:DWORD
ds_read_u16 v9, v6
ds_read_u16 v21, v7
v_add_u32_sdwa v4, v146, v156 dst_sel:DWORD dst_unused:UNUSED_PAD src0_sel:WORD_0 src1_sel:DWORD
v_add_u32_sdwa v5, v146, v156 dst_sel:DWORD dst_unused:UNUSED_PAD src0_sel:WORD_1 src1_sel:DWORD
ds_read_u16 v10, v4
ds_read_u16 v22, v5
v_add_u32_sdwa v6, v147, v156 dst_sel:DWORD dst_unused:UNUSED_PAD src0_sel:WORD_0 src1_sel:DWORD
v_add_u32_sdwa v7, v147, v156 dst_sel:DWORD dst_unused:UNUSED_PAD src0_sel:WORD_1 src1_sel:DWORD
ds_read_u16 v11, v6
ds_read_u16 v23, v7
v_add_u32_sdwa v4, v148, v156 dst_sel:DWORD dst_unused:UNUSED_PAD src0_sel:WORD_0 src1_sel:DWORD
v_add_u32_sdwa v5, v148, v156 dst_sel:DWORD dst_unused:UNUSED_PAD src0_sel:WORD_1 src1_sel:DWORD
ds_read_u16 v12, v4
ds_read_u16 v24, v5
v_add_u32_sdwa v6, v149, v156 dst_sel:DWORD dst_unused:UNUSED_PAD src0_sel:WORD_0 src1_sel:DWORD
v_add_u32_sdwa v7, v149, v156 dst_sel:DWORD dst_unused:UNUSED_PAD src0_sel:WORD_1 src1_sel:DWORD
ds_read_u16 v13, v6
ds_read_u16 v25, v7
v_add_u32_sdwa v4, v150, v156 dst_sel:DWORD dst_unused:UNUSED_PAD src0_sel:WORD_0 src1_sel:DWORD
v_add_u32_sdwa v5, v150, v156 dst_sel:DWORD dst_unused:UNUSED_PAD src0_sel:WORD_1 src1_sel:DWORD
ds_read_u16 v14, v4
ds_read_u16 v26, v5
v_add_u32_sdwa v6, v151, v156 dst_sel:DWORD dst_unused:UNUSED_PAD src0_sel:WORD_0 src1_sel:DWORD
v_add_u32_sdwa v7, v151, v156 dst_sel:DWORD dst_unused:UNUSED_PAD src0_sel:WORD_1 src1_sel:DWORD
ds_read_u16 v15, v6
ds_read_u16 v27, v7
v_add_u32_sdwa v4, v152, v156 dst_sel:DWORD dst_unused:UNUSED_PAD src0_sel:WORD_0 src1_sel:DWORD
v_add_u32_sdwa v5, v152, v156 dst_sel:DWORD dst_unused:UNUSED_PAD src0_sel:WORD_1 src1_sel:DWORD
ds_read_u16 v16, v4
ds_read_u16 v28, v5
v_add_u32_sdwa v6, v153, v156 dst_sel:DWORD dst_unused:UNUSED_PAD src0_sel:WORD_0 src1_sel:DWORD
v_add_u32_sdwa v7, v153, v156 dst_sel:DWORD dst_unused:UNUSED_PAD src0_sel:WORD_1 src1_sel:DWORD
ds_read_u16 v17, v6
ds_read_u16 v29, v7
v_cmp_lt_u32 vcc, 7, v3
v_mov_b32 v4, s46
v_mov_b32 v5, s47
v_cndmask_b32 v52, v4, v5, vcc
v_mov_b32 v4, s22
v_mov_b32 v5, s23
v_cndmask_b32 v53, v4, v5, vcc
v_mov_b32 v4, s52
v_mov_b32 v5, s53
v_cndmask_b32 v54, v4, v5, vcc
v_mul_f32 v53, 0xbfb8aa3b, v53
v_exp_f32 v53, v53
v_and_b32 v54, 255, v54
v_add_f32 v53, 1.0, v53
v_rcp_f32 v53, v53
v_mov_b32 v55, 0
s_waitcnt lgkmcnt(0)
v_lshl_or_b32 v8, v20, 16, v8
v_lshl_or_b32 v9, v21, 16, v9
v_lshl_or_b32 v10, v22, 16, v10
v_lshl_or_b32 v11, v23, 16, v11
v_lshl_or_b32 v12, v24, 16, v12
v_lshl_or_b32 v13, v25, 16, v13
v_lshl_or_b32 v14, v26, 16, v14
v_lshl_or_b32 v15, v27, 16, v15
v_lshl_or_b32 v16, v28, 16, v16
v_lshl_or_b32 v17, v29, 16, v17
LW3:
s_waitcnt vmcnt(0)
LV3:
v_max_u32 v4, v72, v73
v_max3_u32 v4, v4, v74, v75
v_cmp_eq_u32 vcc, -1, v4
s_cbranch_vccnz LR3
LD3:
s_mov_b64 exec, -1
L_round:
v_cmp_gt_u32_e64 s[24:25], v72, s6
v_cmp_gt_u32_e64 s[26:27], v73, s6
v_cmp_gt_u32_e64 s[28:29], v74, s6
v_cmp_gt_u32_e64 s[30:31], v75, s6
v_cmp_gt_u32_e64 s[8:9], v72, s7
v_cmp_gt_u32_e64 s[10:11], v73, s7
v_cmp_gt_u32_e64 s[16:17], v74, s7
v_cmp_gt_u32_e64 s[58:59], v75, s7
s_bcnt1_i32_b64 s24, s[24:25]
s_bcnt1_i32_b64 s26, s[26:27]
s_bcnt1_i32_b64 s28, s[28:29]
s_bcnt1_i32_b64 s30, s[30:31]
s_bcnt1_i32_b64 s8, s[8:9]
s_bcnt1_i32_b64 s10, s[10:11]
s_bcnt1_i32_b64 s16, s[16:17]
s_bcnt1_i32_b64 s58, s[58:59]
s_add_u32 s24, s24, s26
s_add_u32 s28, s28, s30
s_add_u32 s8, s8, s10
s_add_u32 s16, s16, s58
s_add_u32 s24, s24, s28
s_add_u32 s8, s8, s16
s_lshl_b32 s8, s8, 16
s_add_u32 s24, s24, s8
v_mov_b32 v4, s24
s_mov_b64 exec, s[56:57]
ds_add_u32 v119, v4
s_mov_b64 exec, -1
s_waitcnt lgkmcnt(0)
s_barrier
ds_read_b32 v4, v119
s_waitcnt lgkmcnt(0)
v_readfirstlane_b32 s24, v4
s_nop 0
s_and_b32 s25, s24, 0xffff
s_lshr_b32 s24, s24, 16
s_cmp_ge_u32 s25, 8
s_cbranch_scc1 L_rdone
s_cmp_eq_u32 s20, s7
s_cselect_b32 s44, s24, s44
s_cmp_eq_u32 s20, s6
s_cselect_b32 s44, s25, s44
s_cmp_eq_u32 s21, s7
s_cselect_b32 s45, s24, s45
s_cmp_eq_u32 s21, s6
s_cselect_b32 s45, s25, s45
s_cmp_ge_u32 s24, 7
s_cbranch_scc1 L_rdone
s_cmp_ge_u32 s61, 3
s_cbranch_scc1 L_rdone
s_add_u32 s61, s61, 1
v_add_u32 v119, 4, v119
v_mov_b32 v4, v79
s_nop 1
v_max_u32_dpp v4, v4, v4 row_ror:8 row_mask:0xf bank_mask:0xf
s_nop 1
v_max_u32_dpp v4, v4, v4 row_ror:4 row_mask:0xf bank_mask:0xf
s_nop 1
v_max_u32_dpp v4, v4, v4 row_ror:2 row_mask:0xf bank_mask:0xf
s_nop 1
v_max_u32_dpp v4, v4, v4 row_ror:1 row_mask:0xf bank_mask:0xf
v_cmp_ne_u32 vcc, v4, v79
v_readfirstlane_b32 s6, v4
s_nop 0
v_cndmask_b32 v79, 0, v79, vcc
v_mov_b32 v4, v79
s_nop 1
v_max_u32_dpp v4, v4, v4 row_ror:8 row_mask:0xf bank_mask:0xf
s_nop 1
v_max_u32_dpp v4, v4, v4 row_ror:4 row_mask:0xf bank_mask:0xf
s_nop 1
v_max_u32_dpp v4, v4, v4 row_ror:2 row_mask:0xf bank_mask:0xf
s_nop 1
v_max_u32_dpp v4, v4, v4 row_ror:1 row_mask:0xf bank_mask:0xf
v_cmp_ne_u32 vcc, v4, v79
v_readfirstlane_b32 s7, v4
s_nop 0
v_cndmask_b32 v79, 0, v79, vcc
s_branch L_round
L_rdone:
s_mov_b32 s24, 0x00ff00ff
s_cmp_lt_u32 s44, 8
s_cselect_b32 s30, 0, s24
s_cselect_b32 s28, s24, 0
s_not_b32 s24, s24
s_cmp_lt_u32 s45, 8
s_cselect_b32 s31, 0, s24
s_cselect_b32 s29, s24, 0
s_cmp_eq_u32 s50, 0
s_cselect_b32 s31, 0, s31
s_or_b32 s30, s30, s31
s_mov_b32 s31, s30
s_or_b32 s28, s28, s29
s_cbranch_scc0 L_nosel
s_mov_b32 s29, s28
v_cmp_lt_u32 vcc, 7, v3
v_mov_b32 v4, s44
v_mov_b32 v5, s45
v_cndmask_b32 v20, v4, v5, vcc
v_and_b32 v20, 7, v20
v_lshlrev_b32 v22, 7, v20
v_add_u32 v22, 2813952, v22
v_and_b32 v4, 1, v0
v_mul_u32_u24 v4, 122880, v4
v_add_u32 v22, v22, v4
s_and_b32 exec_lo, s28, 0x0303
s_mov_b32 exec_hi, 0
global_store_dwordx4 v22, v[52:55], s[40:41] sc1
s_mov_b64 exec, s[28:29]
v_mul_u32_u24 v21, 1280, v20
v_add_u32 v21, 2803712, v21
v_lshl_add_u32 v21, v2, 6, v21
v_and_b32 v4, 7, v0
v_lshl_add_u32 v21, v4, 3, v21
global_store_dwordx2 v21, v[8:9], s[40:41] offset:0 sc1
global_store_dwordx2 v21, v[10:11], s[40:41] offset:256 sc1
global_store_dwordx2 v21, v[12:13], s[40:41] offset:512 sc1
global_store_dwordx2 v21, v[14:15], s[40:41] offset:768 sc1
global_store_dwordx2 v21, v[16:17], s[40:41] offset:1024 sc1
s_mov_b64 exec, -1
s_cmp_ge_u32 s44, 8
s_cbranch_scc1 L_ns0
s_mul_i32 s26, s44, 1312
s_add_u32 s26, s26, 2782208
v_add_u32 v4, s26, v138
v_add_u32 v5, s26, v139
v_add_u32 v6, s26, v140
global_store_dwordx2 v4, v[60:61], s[40:41] sc1
global_store_dwordx2 v5, v[62:63], s[40:41] sc1
global_store_dword v6, v64, s[40:41] sc1
s_lshl_b32 s26, s44, 4
s_add_u32 s26, s26, 2819328
v_lshl_add_u32 v4, v2, 2, s26
s_mov_b64 exec, 0x10001
global_store_dword v4, v108, s[40:41] sc1
s_mov_b64 exec, -1
L_ns0:
s_cmp_ge_u32 s45, 8
s_cbranch_scc1 L_nosel
s_mul_i32 s26, s45, 1312
s_add_u32 s26, s26, 2782208
v_add_u32 v4, s26, v141
v_add_u32 v5, s26, v142
v_add_u32 v6, s26, v143
global_store_dwordx2 v4, v[66:67], s[40:41] sc1
global_store_dwordx2 v5, v[68:69], s[40:41] sc1
global_store_dword v6, v70, s[40:41] sc1
s_lshl_b32 s26, s45, 4
s_add_u32 s26, s26, 2819328
v_lshl_add_u32 v4, v2, 2, s26
s_mov_b64 exec, 0x10001
global_store_dword v4, v160, s[40:41] sc1
s_mov_b64 exec, -1
L_nosel:
s_cmp_eq_u32 s30, 0
s_cbranch_scc1 L_noout
s_mov_b64 exec, s[30:31]
global_store_dwordx2 v158, v[8:9], s[36:37] offset:0 sc1
global_store_dwordx2 v158, v[10:11], s[36:37] offset:256 sc1
global_store_dwordx2 v158, v[12:13], s[36:37] offset:512 sc1
global_store_dwordx2 v158, v[14:15], s[36:37] offset:768 sc1
global_store_dwordx2 v158, v[16:17], s[36:37] offset:1024 sc1
s_mov_b64 exec, -1
L_noout:
s_or_b32 s24, s2, s3
s_cbranch_scc1 L_fin
s_load_dword s16, s[40:41], 0
v_mov_b32 v4, 0
s_waitcnt lgkmcnt(0)
s_add_u32 s16, s16, 1
v_mov_b32 v5, s16
s_mov_b64 exec, 1
global_store_dword v4, v5, s[40:41]
s_mov_b64 exec, -1
s_branch L_fin
L_wm0:
s_branch L_wm1
L_cand:
s_setprio 3
s_cmp_lt_i32 s52, 0
s_cbranch_scc1 L_cs0
v_lshlrev_b32 v4, 16, v112
v_and_b32 v5, 0xffff0000, v112
v_pk_add_f32 v[32:33], v[32:33], v[4:5]
v_cvt_pk_bf16_f32 v60, v32, v33
v_lshlrev_b32 v4, 16, v113
v_and_b32 v5, 0xffff0000, v113
v_pk_add_f32 v[34:35], v[34:35], v[4:5]
v_cvt_pk_bf16_f32 v61, v34, v35
v_lshlrev_b32 v4, 16, v114
v_and_b32 v5, 0xffff0000, v114
v_pk_add_f32 v[36:37], v[36:37], v[4:5]
v_cvt_pk_bf16_f32 v62, v36, v37
v_lshlrev_b32 v4, 16, v117
v_and_b32 v5, 0xffff0000, v117
v_pk_add_f32 v[38:39], v[38:39], v[4:5]
v_cvt_pk_bf16_f32 v63, v38, v39
v_lshlrev_b32 v4, 16, v116
v_and_b32 v5, 0xffff0000, v116
v_pk_add_f32 v[40:41], v[40:41], v[4:5]
v_cvt_pk_bf16_f32 v64, v40, v41
s_mul_i32 s26, s52, 1312
s_add_u32 s26, s26, 2760704
v_add_u32 v4, s26, v138
v_add_u32 v5, s26, v139
v_add_u32 v6, s26, v140
global_store_dwordx2 v4, v[60:61], s[40:41] sc1
global_store_dwordx2 v5, v[62:63], s[40:41] sc1
global_store_dword v6, v64, s[40:41] sc1
L_cs0:
s_cmp_lt_i32 s53, 0
s_cbranch_scc1 L_cs1
v_lshlrev_b32 v4, 16, v112
v_and_b32 v5, 0xffff0000, v112
v_pk_add_f32 v[42:43], v[42:43], v[4:5]
v_cvt_pk_bf16_f32 v66, v42, v43
v_lshlrev_b32 v4, 16, v118
v_and_b32 v5, 0xffff0000, v118
v_pk_add_f32 v[44:45], v[44:45], v[4:5]
v_cvt_pk_bf16_f32 v67, v44, v45
v_lshlrev_b32 v4, 16, v114
v_and_b32 v5, 0xffff0000, v114
v_pk_add_f32 v[46:47], v[46:47], v[4:5]
v_cvt_pk_bf16_f32 v68, v46, v47
v_lshlrev_b32 v4, 16, v115
v_and_b32 v5, 0xffff0000, v115
v_pk_add_f32 v[48:49], v[48:49], v[4:5]
v_cvt_pk_bf16_f32 v69, v48, v49
v_lshlrev_b32 v4, 16, v116
v_and_b32 v5, 0xffff0000, v116
v_pk_add_f32 v[50:51], v[50:51], v[4:5]
v_cvt_pk_bf16_f32 v70, v50, v51
s_mul_i32 s26, s53, 1312
s_add_u32 s26, s26, 2760704
v_add_u32 v4, s26, v141
v_add_u32 v5, s26, v142
v_add_u32 v6, s26, v143
global_store_dwordx2 v4, v[66:67], s[40:41] sc1
global_store_dwordx2 v5, v[68:69], s[40:41] sc1
global_store_dword v6, v70, s[40:41] sc1
L_cs1:
s_cmp_eq_u32 s55, 0
s_cbranch_scc1 L_nc
L_cst:
s_cmp_lt_i32 s52, 0
s_cbranch_scc1 L_ct0
s_lshl_b32 s26, s52, 4
s_add_u32 s26, s26, 2819072
v_lshl_add_u32 v4, v2, 2, s26
s_mov_b64 exec, 0x10001
global_store_dword v4, v108, s[40:41] sc1
s_mov_b64 exec, -1
L_ct0:
s_cmp_lt_i32 s53, 0
s_cbranch_scc1 L_ct1
s_lshl_b32 s26, s53, 4
s_add_u32 s26, s26, 2819072
v_lshl_add_u32 v4, v2, 2, s26
s_mov_b64 exec, 0x10001
global_store_dword v4, v160, s[40:41] sc1
s_mov_b64 exec, -1
L_ct1:
s_setprio 0
s_cmp_eq_u32 s55, 0
s_cbranch_scc1 L_nc1
s_branch L_nc2
L_wm1:
s_branch L_b1
L_u0:
s_waitcnt lgkmcnt(0)
v_mfma_f32_16x16x32_bf16 v[52:55], v[28:31], v[96:99], 0
v_mfma_f32_16x16x32_bf16 v[56:59], v[28:31], v[100:103], 0
s_branch L_u1
L_smr:
s_add_u32 s13, s13, 1
s_cmp_gt_u32 s13, 0x10000
s_cbranch_scc1 L_smd
ds_read_b128 v[32:35], v157 offset:22528
s_branch L_sm
LR0:
s_add_u32 s15, s15, 1
s_cmp_lt_u32 s15, 40000
s_cbranch_scc0 LD0
s_mov_b64 exec, vcc
s_sleep 2
global_load_dwordx4 v[40:43], v112, s[40:41] sc1
global_load_dwordx4 v[44:47], v113, s[40:41] sc1
s_branch LW0
L_l2:
global_load_dword v71, v19, s[40:41] offset:1024 sc1
s_branch L_nl
LR1:
s_add_u32 s15, s15, 1
s_cmp_lt_u32 s15, 40000
s_cbranch_scc0 LD1
s_mov_b64 exec, vcc
s_sleep 2
global_load_dwordx2 v[112:113], v128, s[40:41] sc1
global_load_dwordx2 v[114:115], v129, s[40:41] sc1
global_load_dword v116, v130, s[40:41] sc1
s_branch LW1
L_l3:
v_cmp_eq_u32 vcc, -1, v71
s_cbranch_vccnz L_nc
s_mov_b32 s55, 0
v_cmp_eq_u32_e64 s[24:25], s46, v71
v_cmp_eq_u32_e64 s[26:27], s47, v71
s_ff1_i32_b64 s52, s[24:25]
s_ff1_i32_b64 s53, s[26:27]
s_cmp_eq_u32 s50, 0
s_cselect_b32 s53, -1, s53
s_and_b32 s54, s52, s53
s_cmp_lt_i32 s54, 0
s_cbranch_scc1 L_nc
s_cmp_eq_u32 s50, 0
s_cselect_b32 s26, 0, s26
s_or_b32 exec_lo, s24, s26
s_mov_b32 exec_hi, exec_lo
global_store_dword v155, v155, s[40:41] sc1
global_store_dword v121, v155, s[40:41] sc1
s_mov_b64 exec, -1
s_branch L_cand
LR2:
s_add_u32 s15, s15, 1
s_cmp_lt_u32 s15, 40000
s_cbranch_scc0 LD2
s_mov_b64 exec, vcc
s_sleep 2
global_load_dword v71, v19, s[40:41] sc1
s_branch LW2
LR3:
s_add_u32 s15, s15, 1
s_cmp_lt_u32 s15, 40000
s_cbranch_scc0 LD3
s_mov_b64 exec, vcc
s_sleep 2
global_load_dwordx4 v[72:75], v154, s[40:41] sc1
s_branch LW3
L_a8b:
v_mov_b32 v112, 0
v_mov_b32 v113, 0
v_mov_b32 v121, 0
s_waitcnt lgkmcnt(0)
global_load_ushort v87, v87, s[28:29]
s_cmp_eq_u32 s3, 8
s_cbranch_scc1 L_wm0
v_cvt_f32_u32 v20, s2
v_mul_f32 v20, 0x3b800000, v20
v_cos_f32 v21, v20
v_sin_f32 v22, v20
v_and_b32 v6, 7, v0
v_and_b32 v23, 8, v0
v_cmp_eq_u32 vcc, 0, v6
s_nop 1
v_cndmask_b32 v21, 1.0, v21, vcc
v_cndmask_b32 v22, 0, v22, vcc
v_lshlrev_b32 v24, 28, v23
s_cmp_eq_u32 s2, 0
s_cselect_b64 s[8:9], vcc, 0
v_cndmask_b32_e64 v24, v24, 0, s[8:9]
v_xor_b32 v21, v21, v24
v_sub_u32 v24, 8, v6
v_and_b32 v24, 7, v24
v_add3_u32 v24, v24, v23, 16
v_sub_u32 v25, 24, v23
v_cmp_eq_u32 vcc, 1, v2
s_nop 1
v_cndmask_b32 v112, v3, v24, vcc
v_cndmask_b32 v113, 1.0, v21, vcc
v_cmp_eq_u32 vcc, 2, v2
s_nop 1
v_cndmask_b32 v112, v112, v25, vcc
v_cndmask_b32 v113, v113, v22, vcc
v_cmp_eq_u32 vcc, 3, v2
s_nop 1
v_cndmask_b32_e64 v113, v113, 0, vcc
v_lshlrev_b32 v112, 2, v112
s_lshl_b32 s8, s2, 7
s_add_u32 s8, s8, 65536
v_lshl_add_u32 v120, v3, 1, s8
s_branch L_b1
L_a10:
s_setprio 2
v_lshrrev_b32 v20, 2, v3
v_and_b32 v21, 3, v0
v_mad_u32_u24 v20, v20, 5, v21
v_cvt_f32_u32 v28, v2
v_lshrrev_b32 v22, 1, v20
v_and_b32 v24, 1, v20
v_cmp_eq_u32 vcc, 1, v20
s_nop 1
v_cndmask_b32_e64 v22, v22, 10, vcc
v_cndmask_b32_e64 v24, v24, 0, vcc
v_cmp_eq_u32 vcc, 3, v21
s_nop 1
v_cndmask_b32_e64 v22, v22, 0, vcc
v_cndmask_b32_e64 v24, v24, 0, vcc
v_cvt_f32_u32 v22, v22
v_cvt_f32_u32 v24, v24
v_mul_f32 v22, 0x3d4ccccd, v22
v_mul_f32 v24, 0x3e800000, v24
v_fmac_f32 v24, v28, v22
v_mul_f32 v22, 4.0, v22
v_cos_f32 v29, v24
v_add_f32 v24, v24, v22
v_cos_f32 v30, v24
v_add_f32 v24, v24, v22
v_cos_f32 v31, v24
v_add_f32 v24, v24, v22
v_cos_f32 v32, v24
v_add_f32 v24, v24, v22
v_cos_f32 v33, v24
v_cvt_pk_bf16_f32 v36, v29, v30
v_cvt_pk_bf16_f32 v37, v31, v32
v_cvt_pk_bf16_f32 v38, v33, 0
v_mov_b32 v39, 0
v_add_u32 v20, 3, v20
v_lshrrev_b32 v22, 1, v20
v_and_b32 v24, 1, v20
v_cvt_f32_u32 v22, v22
v_cvt_f32_u32 v24, v24
v_mul_f32 v22, 0x3d4ccccd, v22
v_mul_f32 v24, 0x3e800000, v24
v_fmac_f32 v24, v28, v22
v_mul_f32 v22, 4.0, v22
v_cos_f32 v29, v24
v_add_f32 v24, v24, v22
v_cos_f32 v30, v24
v_add_f32 v24, v24, v22
v_cos_f32 v31, v24
v_add_f32 v24, v24, v22
v_cos_f32 v32, v24
v_add_f32 v24, v24, v22
v_cos_f32 v33, v24
v_cvt_pk_bf16_f32 v40, v29, v30
v_cvt_pk_bf16_f32 v41, v31, v32
v_cvt_pk_bf16_f32 v42, v33, 0
v_mov_b32 v43, 0
ds_write_b128 v157, v[36:39] offset:53248
ds_write_b128 v157, v[40:43] offset:54272
s_waitcnt lgkmcnt(0)
s_barrier
s_setprio 1
s_lshl_b32 s7, s2, 7
s_waitcnt lgkmcnt(0)
s_load_dword s6, s[40:41], 0
s_add_u32 s7, s7, 16384
v_mov_b32 v17, s7
v_add_u32 v18, 98304, v17
s_sub_u32 s7, 256, s2
s_cmp_eq_u32 s2, 0
s_cselect_b32 s7, 128, s7
v_lshrrev_b32 v20, 1, v3
v_and_b32 v21, 1, v0
v_lshrrev_b32 v22, 1, v2
v_and_b32 v23, 1, v2
v_mov_b32 v24, s7
v_mov_b32 v25, s2
v_cmp_eq_u32 vcc, 1, v22
s_nop 1
v_cndmask_b32 v24, v25, v24, vcc
v_lshl_add_u32 v24, v23, 10, v24
v_subrev_u32 v25, 4, v20
v_mul_i32_i24 v24, v24, v25
v_lshl_add_u32 v24, v21, 9, v24
v_cmp_gt_u32 vcc, v22, v21
s_cmp_lg_u32 s2, 0
s_cselect_b32 s49, 1024, 0
v_mov_b32 v25, s49
v_cndmask_b32 v25, 0, v25, vcc
v_add_u32 v24, v24, v25
v_and_b32 v24, 2047, v24
v_cvt_f32_u32 v24, v24
v_cvt_f32_u32 v25, v20
v_mul_f32 v24, 0x3a000000, v24
v_mul_f32 v25, 0x3e000000, v25
v_cmp_eq_u32 vcc, v22, v21
s_cselect_b64 s[52:53], -1, 0
s_or_b64 vcc, vcc, s[52:53]
v_cos_f32 v60, v24
v_sin_f32 v64, v24
v_add_f32 v24, v24, v25
v_cos_f32 v61, v24
v_sin_f32 v65, v24
v_add_f32 v24, v24, v25
v_cos_f32 v62, v24
v_sin_f32 v66, v24
v_add_f32 v24, v24, v25
v_cos_f32 v63, v24
v_sin_f32 v67, v24
v_cndmask_b32 v60, 0, v60, vcc
v_cndmask_b32 v61, 0, v61, vcc
v_cndmask_b32 v62, 0, v62, vcc
v_cndmask_b32 v63, 0, v63, vcc
v_cndmask_b32 v64, 0, v64, vcc
v_cndmask_b32 v65, 0, v65, vcc
v_cndmask_b32 v66, 0, v66, vcc
v_cndmask_b32 v67, 0, v67, vcc
s_mov_b32 s60, 0x3acccccd
s_mov_b32 s61, 0x3acccccd
v_mov_b32 v86, 0x3727c5ac
v_and_b32 v165, 3, v0
v_lshl_add_u32 v165, v2, 2, v165
v_lshlrev_b32 v166, 4, v165
v_lshlrev_b32 v165, 2, v165
s_movk_i32 m0, 25088
s_nop 0
global_load_lds_dwordx4 v157, s[42:43]
global_load_lds_dwordx4 v157, s[42:43] offset:1024
s_waitcnt lgkmcnt(0)
s_add_u32 s6, s6, 1
s_sub_u32 s8, s2, 112
s_and_b32 s8, s8, 31
s_lshl_b32 s8, s8, 7
s_add_u32 s8, s8, 81920
v_lshrrev_b32 v5, 3, v1
v_lshl_add_u32 v5, v5, 12, s8
v_lshl_add_u32 v16, v6, 4, v5
v_mov_b32 v8, s6
v_mov_b32 v9, s6
v_mov_b32 v10, s6
v_mov_b32 v11, s6
v_mov_b32 v12, -1
v_mov_b32 v13, -1
v_mov_b32 v14, -1
v_mov_b32 v15, -1
ds_write_b128 v157, v[12:15] offset:22528
s_waitcnt vmcnt(0)
global_load_dword v21, v17, s[40:41] sc1
s_setprio 3
s_waitcnt lgkmcnt(0)
s_barrier
ds_read_b128 v[36:39], v166 offset:22016
ds_read_b32 v40, v165 offset:21504
global_load_dword v20, v18, s[40:41] sc1
s_waitcnt lgkmcnt(0)
v_add_f32 v36, v36, v37
v_add_f32 v38, v38, v39
v_mul_f32 v40, s60, v40
v_add_f32 v36, v36, v38
v_fma_f32 v40, -v40, v40, v86
v_fmac_f32 v40, s60, v36
v_max_f32 v40, v40, v86
v_rsq_f32 v40, v40
s_nop 1
v_mul_f32_dpp v60, v40, v60 quad_perm:[0,0,0,0] row_mask:0xf bank_mask:0xf
v_mul_f32_dpp v61, v40, v61 quad_perm:[1,1,1,1] row_mask:0xf bank_mask:0xf
v_cvt_pk_bf16_f32 v32, v60, v61
v_mul_f32_dpp v62, v40, v62 quad_perm:[2,2,2,2] row_mask:0xf bank_mask:0xf
v_mul_f32_dpp v63, v40, v63 quad_perm:[3,3,3,3] row_mask:0xf bank_mask:0xf
v_cvt_pk_bf16_f32 v33, v62, v63
v_mul_f32_dpp v64, v40, v64 quad_perm:[0,0,0,0] row_mask:0xf bank_mask:0xf
v_mul_f32_dpp v65, v40, v65 quad_perm:[1,1,1,1] row_mask:0xf bank_mask:0xf
v_cvt_pk_bf16_f32 v34, v64, v65
v_mul_f32_dpp v66, v40, v66 quad_perm:[2,2,2,2] row_mask:0xf bank_mask:0xf
v_mul_f32_dpp v67, v40, v67 quad_perm:[3,3,3,3] row_mask:0xf bank_mask:0xf
v_cvt_pk_bf16_f32 v35, v66, v67
s_waitcnt vmcnt(1)
v_cmp_ne_u32 vcc, s6, v21
s_cbranch_vccz LD4
LW4:
s_waitcnt vmcnt(0)
LV4:
v_cmp_ne_u32 vcc, s6, v20
s_cbranch_vccnz LR4
LD4:
s_mov_b64 exec, -1
ds_write_b128 v157, v[32:35] offset:22528
s_cmp_lt_u32 s2, 120
s_cbranch_scc1 L_h1
global_store_dwordx4 v16, v[8:11], s[40:41] sc1
L_h1:
s_barrier
s_setprio 0
L_flagchk:
s_and_b32 s7, s2, 7
s_lshl_b32 s7, s7, 12
s_add_u32 s7, s7, 81920
v_lshl_add_u32 v4, v1, 7, s7
s_mov_b64 exec, 0xffff
global_load_dword v20, v4, s[40:41] offset:0 sc1
LW5:
s_waitcnt vmcnt(0)
LV5:
v_cmp_ne_u32 vcc, s6, v20
s_cbranch_vccnz LR5
LD5:
s_mov_b64 exec, -1
s_mov_b64 exec, 0xff
global_load_dword v20, v4, s[40:41] offset:3072 sc1
s_barrier
LW6:
s_waitcnt vmcnt(0)
LV6:
v_cmp_ne_u32 vcc, s6, v20
s_cbranch_vccnz LR6
LD6:
s_mov_b64 exec, -1
s_barrier
s_branch L_fin
L_agg:
s_and_b32 s7, s4, 7
s_lshl_b32 s7, s7, 7
s_cmp_lt_u32 s4, 8
s_cselect_b32 s8, 0x4000, 0
s_cselect_b32 s9, 0, 3072
s_add_u32 s8, s8, s7
s_add_u32 s8, s8, 32768
v_lshl_add_u32 v4, v1, 10, s8
s_add_u32 s8, s7, s9
s_add_u32 s8, s8, 81920
v_lshrrev_b32 v5, 3, v1
v_lshl_add_u32 v5, v5, 12, s8
v_lshl_add_u32 v5, v6, 4, v5
s_mov_b64 exec, 0xffff
global_load_dword v20, v4, s[40:41] sc1
LW7:
s_waitcnt vmcnt(0)
LV7:
v_cmp_ne_u32 vcc, s6, v20
s_cbranch_vccnz LR7
LD7:
s_mov_b64 exec, -1
global_store_dwordx4 v5, v[8:11], s[40:41] sc1
s_branch L_flagchk
L_fw:
s_cmp_ge_u32 s14, 216
s_cbranch_scc1 L_fw1
s_mov_b32 m0, 103552
s_nop 0
global_load_lds_dwordx4 v157, s[42:43] offset:1024
global_load_lds_dwordx4 v157, s[42:43] offset:2048
L_fw1:
s_waitcnt vmcnt(0)
s_barrier
s_and_b32 s7, s2, 7
s_lshl_b32 s7, s7, 12
s_add_u32 s7, s7, 81920
v_lshl_add_u32 v4, v1, 7, s7
s_mov_b64 exec, 0xff
global_load_dword v20, v4, s[40:41] offset:3072 sc1
LW8:
s_waitcnt vmcnt(0)
LV8:
v_cmp_ne_u32 vcc, s6, v20
s_cbranch_vccnz LR8
LD8:
s_mov_b64 exec, -1
s_and_b32 s9, s2, 7
s_lshl_b32 s9, s9, 11
s_add_u32 s9, s9, 2940928
s_cmp_ge_u32 s14, 216
s_cselect_b32 s7, 7, 15
s_cselect_b32 s8, 2819584, s9
v_min_u32 v4, s7, v1
v_lshl_add_u32 v4, v4, 7, s8
global_load_dword v20, v4, s[40:41] sc1
LW9:
s_waitcnt vmcnt(0)
LV9:
v_cmp_eq_u32 vcc, -1, v20
s_cbranch_vccnz LR9
LD9:
s_mov_b64 exec, -1
s_barrier
s_cmp_ge_u32 s14, 216
s_cbranch_scc1 L_fin
v_lshlrev_b32 v4, 7, v6
v_add_u32 v4, 2936840, v4
v_mov_b32 v5, 139264
s_barrier
v_min_u32 v7, 7, v1
v_lshlrev_b32 v7, 7, v7
v_add_u32 v7, 2819584, v7
global_load_dword v20, v7, s[40:41] sc1
LW10:
s_waitcnt vmcnt(0)
LV10:
v_cmp_eq_u32 vcc, -1, v20
s_cbranch_vccnz LR10
LD10:
s_mov_b64 exec, -1
global_load_dword v20, v4, s[40:41] sc1
LW11:
s_waitcnt vmcnt(0)
LV11:
v_cmp_eq_u32 vcc, -1, v20
s_cbranch_vccnz LR11
LD11:
s_mov_b64 exec, -1
v_cmp_lt_u32 vcc, 15, v20
s_nop 1
v_mov_b32 v6, vcc_lo
ds_write_b32 v5, v6
s_waitcnt lgkmcnt(0)
s_barrier
s_branch L_fin
L_bf3:
s_cmp_ge_u32 s2, 160
s_cbranch_scc1 L_f
v_mov_b32 v158, 0
s_and_b32 s62, s2, 7
s_lshr_b32 s56, s2, 4
s_mul_i32 s57, s62, 10
s_add_u32 s57, s57, s56
s_lshl_b32 s57, s57, 14
s_add_u32 s57, s57, 131072
v_lshl_add_u32 v112, v0, 4, s57
v_add_u32 v113, 0x2000, v112
v_lshlrev_b32 v6, 1, v0
v_and_b32 v6, 32, v6
v_and_b32 v7, 64, v0
v_or_b32 v6, v6, v7
v_lshlrev_b32 v7, 4, v0
v_xor_b32 v114, v6, v7
s_lshl_b32 s56, s56, 7
s_add_u32 s56, s56, 1441792
s_lshl_b32 s58, s3, 8
s_add_u32 s58, s58, s5
s_lshl2_add_u32 s59, s62, s58
s_mulk_i32 s59, 1280
s_add_u32 s59, s59, s56
s_lshl_b32 s60, s62, 2
s_add_u32 s60, s60, 995
s_sub_u32 s60, s60, s58
s_mulk_i32 s60, 1280
s_add_u32 s60, s60, s56
s_add_u32 s60, s60, 64
v_and_b32 v4, 7, v0
v_mul_u32_u24 v4, 40960, v4
v_lshrrev_b32 v5, 3, v3
v_lshl_add_u32 v4, v5, 6, v4
v_lshlrev_b32 v5, 4, v2
v_add3_u32 v120, v4, v5, s59
v_sub_u32 v121, s60, v4
v_add_u32 v121, v121, v5
v_lshrrev_b32 v5, 2, v3
v_lshl_add_u32 v4, v2, 3, v5
v_lshlrev_b32 v4, 7, v4
v_and_b32 v5, 3, v0
v_lshl_add_u32 v4, v5, 3, v4
v_bfe_u32 v5, v0, 3, 2
v_lshl_add_u32 v116, v5, 5, v4
v_xor_b32 v117, 64, v116
v_xor_b32 v118, 32, v116
v_xor_b32 v119, 96, v116
s_branch L_b2
L_f:
s_cmp_eq_u32 s14, 214
s_cbranch_scc1 L_fin
s_cmp_lg_u32 s14, 215
s_cbranch_scc1 L_fx
L_sel:
s_cmp_ge_u32 s3, 4
s_cbranch_scc1 L_fin
s_add_u32 s56, s3, 8
s_lshl_b32 s56, s56, 4
s_add_u32 s56, s56, 1
v_and_b32 v16, 7, v0
v_lshl_add_u32 v16, v16, 1, s56
v_and_b32 v17, 8, v0
v_lshl_add_u32 v16, v17, 3, v16
v_cvt_f32_u32 v16, v16
v_lshlrev_b32 v17, 3, v2
v_cvt_f32_u32 v17, v17
v_mul_f32 v16, 0xbb000000, v16
v_cos_f32 v18, v16
v_mul_f32 v17, v17, v16
v_mul_f32 v20, 0x41f80000, v16
v_add_f32 v18, v18, v18
v_cos_f32 v24, v17
v_sin_f32 v25, v17
v_add_f32 v17, v17, v16
v_cos_f32 v26, v17
v_sin_f32 v27, v17
v_add_f32 v17, v17, v20
v_pk_fma_f32 v[28:29], v[26:27], v[18:19], v[24:25] op_sel_hi:[1,0,1] neg_lo:[0,0,1] neg_hi:[0,0,1]
v_pk_fma_f32 v[30:31], v[28:29], v[18:19], v[26:27] op_sel_hi:[1,0,1] neg_lo:[0,0,1] neg_hi:[0,0,1]
v_pk_fma_f32 v[32:33], v[30:31], v[18:19], v[28:29] op_sel_hi:[1,0,1] neg_lo:[0,0,1] neg_hi:[0,0,1]
v_pk_fma_f32 v[34:35], v[32:33], v[18:19], v[30:31] op_sel_hi:[1,0,1] neg_lo:[0,0,1] neg_hi:[0,0,1]
v_pk_fma_f32 v[36:37], v[34:35], v[18:19], v[32:33] op_sel_hi:[1,0,1] neg_lo:[0,0,1] neg_hi:[0,0,1]
v_pk_fma_f32 v[38:39], v[36:37], v[18:19], v[34:35] op_sel_hi:[1,0,1] neg_lo:[0,0,1] neg_hi:[0,0,1]
v_lshlrev_b32 v21, 31, v0
v_xor_b32 v21, -1.0, v21
v_cmp_eq_u32 vcc, 0, v2
s_nop 1
v_cndmask_b32 v25, v25, v21, vcc
v_cvt_pk_bf16_f32 v88, v24, v26
v_cvt_pk_bf16_f32 v104, v25, v27
v_cvt_pk_bf16_f32 v89, v28, v30
v_cvt_pk_bf16_f32 v105, v29, v31
v_cvt_pk_bf16_f32 v90, v32, v34
v_cvt_pk_bf16_f32 v106, v33, v35
v_cvt_pk_bf16_f32 v91, v36, v38
v_cvt_pk_bf16_f32 v107, v37, v39
v_cos_f32 v24, v17
v_sin_f32 v25, v17
v_add_f32 v17, v17, v16
v_cos_f32 v26, v17
v_sin_f32 v27, v17
v_add_f32 v17, v17, v20
v_pk_fma_f32 v[28:29], v[26:27], v[18:19], v[24:25] op_sel_hi:[1,0,1] neg_lo:[0,0,1] neg_hi:[0,0,1]
v_pk_fma_f32 v[30:31], v[28:29], v[18:19], v[26:27] op_sel_hi:[1,0,1] neg_lo:[0,0,1] neg_hi:[0,0,1]
v_pk_fma_f32 v[32:33], v[30:31], v[18:19], v[28:29] op_sel_hi:[1,0,1] neg_lo:[0,0,1] neg_hi:[0,0,1]
v_pk_fma_f32 v[34:35], v[32:33], v[18:19], v[30:31] op_sel_hi:[1,0,1] neg_lo:[0,0,1] neg_hi:[0,0,1]
v_pk_fma_f32 v[36:37], v[34:35], v[18:19], v[32:33] op_sel_hi:[1,0,1] neg_lo:[0,0,1] neg_hi:[0,0,1]
v_pk_fma_f32 v[38:39], v[36:37], v[18:19], v[34:35] op_sel_hi:[1,0,1] neg_lo:[0,0,1] neg_hi:[0,0,1]
v_cvt_pk_bf16_f32 v92, v24, v26
v_cvt_pk_bf16_f32 v108, v25, v27
v_cvt_pk_bf16_f32 v93, v28, v30
v_cvt_pk_bf16_f32 v109, v29, v31
v_cvt_pk_bf16_f32 v94, v32, v34
v_cvt_pk_bf16_f32 v110, v33, v35
v_cvt_pk_bf16_f32 v95, v36, v38
v_cvt_pk_bf16_f32 v111, v37, v39
v_cos_f32 v24, v17
v_sin_f32 v25, v17
v_add_f32 v17, v17, v16
v_cos_f32 v26, v17
v_sin_f32 v27, v17
v_add_f32 v17, v17, v20
v_pk_fma_f32 v[28:29], v[26:27], v[18:19], v[24:25] op_sel_hi:[1,0,1] neg_lo:[0,0,1] neg_hi:[0,0,1]
v_pk_fma_f32 v[30:31], v[28:29], v[18:19], v[26:27] op_sel_hi:[1,0,1] neg_lo:[0,0,1] neg_hi:[0,0,1]
v_pk_fma_f32 v[32:33], v[30:31], v[18:19], v[28:29] op_sel_hi:[1,0,1] neg_lo:[0,0,1] neg_hi:[0,0,1]
v_pk_fma_f32 v[34:35], v[32:33], v[18:19], v[30:31] op_sel_hi:[1,0,1] neg_lo:[0,0,1] neg_hi:[0,0,1]
v_pk_fma_f32 v[36:37], v[34:35], v[18:19], v[32:33] op_sel_hi:[1,0,1] neg_lo:[0,0,1] neg_hi:[0,0,1]
v_pk_fma_f32 v[38:39], v[36:37], v[18:19], v[34:35] op_sel_hi:[1,0,1] neg_lo:[0,0,1] neg_hi:[0,0,1]
v_cvt_pk_bf16_f32 v96, v24, v26
v_cvt_pk_bf16_f32 v112, v25, v27
v_cvt_pk_bf16_f32 v97, v28, v30
v_cvt_pk_bf16_f32 v113, v29, v31
v_cvt_pk_bf16_f32 v98, v32, v34
v_cvt_pk_bf16_f32 v114, v33, v35
v_cvt_pk_bf16_f32 v99, v36, v38
v_cvt_pk_bf16_f32 v115, v37, v39
v_cos_f32 v24, v17
v_sin_f32 v25, v17
v_add_f32 v17, v17, v16
v_cos_f32 v26, v17
v_sin_f32 v27, v17
v_add_f32 v17, v17, v20
v_pk_fma_f32 v[28:29], v[26:27], v[18:19], v[24:25] op_sel_hi:[1,0,1] neg_lo:[0,0,1] neg_hi:[0,0,1]
v_pk_fma_f32 v[30:31], v[28:29], v[18:19], v[26:27] op_sel_hi:[1,0,1] neg_lo:[0,0,1] neg_hi:[0,0,1]
v_pk_fma_f32 v[32:33], v[30:31], v[18:19], v[28:29] op_sel_hi:[1,0,1] neg_lo:[0,0,1] neg_hi:[0,0,1]
v_pk_fma_f32 v[34:35], v[32:33], v[18:19], v[30:31] op_sel_hi:[1,0,1] neg_lo:[0,0,1] neg_hi:[0,0,1]
v_pk_fma_f32 v[36:37], v[34:35], v[18:19], v[32:33] op_sel_hi:[1,0,1] neg_lo:[0,0,1] neg_hi:[0,0,1]
v_pk_fma_f32 v[38:39], v[36:37], v[18:19], v[34:35] op_sel_hi:[1,0,1] neg_lo:[0,0,1] neg_hi:[0,0,1]
v_cvt_pk_bf16_f32 v100, v24, v26
v_cvt_pk_bf16_f32 v116, v25, v27
v_cvt_pk_bf16_f32 v101, v28, v30
v_cvt_pk_bf16_f32 v117, v29, v31
v_cvt_pk_bf16_f32 v102, v32, v34
v_cvt_pk_bf16_f32 v118, v33, v35
v_cvt_pk_bf16_f32 v103, v36, v38
v_cvt_pk_bf16_f32 v119, v37, v39
s_mov_b32 s56, s3
s_lshl_b32 s56, s56, 4
s_add_u32 s56, s56, 1
v_and_b32 v16, 7, v0
v_lshl_add_u32 v16, v16, 1, s56
v_and_b32 v17, 8, v0
v_lshl_add_u32 v16, v17, 3, v16
v_cvt_f32_u32 v16, v16
v_lshlrev_b32 v17, 3, v2
v_cvt_f32_u32 v17, v17
v_mul_f32 v16, 0xbb000000, v16
v_cos_f32 v18, v16
v_mul_f32 v17, v17, v16
v_mul_f32 v20, 0x41f80000, v16
v_add_f32 v18, v18, v18
v_cos_f32 v24, v17
v_sin_f32 v25, v17
v_add_f32 v17, v17, v16
v_cos_f32 v26, v17
v_sin_f32 v27, v17
v_add_f32 v17, v17, v20
v_pk_fma_f32 v[28:29], v[26:27], v[18:19], v[24:25] op_sel_hi:[1,0,1] neg_lo:[0,0,1] neg_hi:[0,0,1]
v_pk_fma_f32 v[30:31], v[28:29], v[18:19], v[26:27] op_sel_hi:[1,0,1] neg_lo:[0,0,1] neg_hi:[0,0,1]
v_pk_fma_f32 v[32:33], v[30:31], v[18:19], v[28:29] op_sel_hi:[1,0,1] neg_lo:[0,0,1] neg_hi:[0,0,1]
v_pk_fma_f32 v[34:35], v[32:33], v[18:19], v[30:31] op_sel_hi:[1,0,1] neg_lo:[0,0,1] neg_hi:[0,0,1]
v_pk_fma_f32 v[36:37], v[34:35], v[18:19], v[32:33] op_sel_hi:[1,0,1] neg_lo:[0,0,1] neg_hi:[0,0,1]
v_pk_fma_f32 v[38:39], v[36:37], v[18:19], v[34:35] op_sel_hi:[1,0,1] neg_lo:[0,0,1] neg_hi:[0,0,1]
v_lshlrev_b32 v21, 31, v0
v_xor_b32 v21, -1.0, v21
v_cmp_eq_u32 vcc, 0, v2
s_nop 1
v_cndmask_b32 v25, v25, v21, vcc
v_cvt_pk_bf16_f32 v56, v24, v26
v_cvt_pk_bf16_f32 v72, v25, v27
v_cvt_pk_bf16_f32 v57, v28, v30
v_cvt_pk_bf16_f32 v73, v29, v31
v_cvt_pk_bf16_f32 v58, v32, v34
v_cvt_pk_bf16_f32 v74, v33, v35
v_cvt_pk_bf16_f32 v59, v36, v38
v_cvt_pk_bf16_f32 v75, v37, v39
v_cos_f32 v24, v17
v_sin_f32 v25, v17
v_add_f32 v17, v17, v16
v_cos_f32 v26, v17
v_sin_f32 v27, v17
v_add_f32 v17, v17, v20
v_pk_fma_f32 v[28:29], v[26:27], v[18:19], v[24:25] op_sel_hi:[1,0,1] neg_lo:[0,0,1] neg_hi:[0,0,1]
v_pk_fma_f32 v[30:31], v[28:29], v[18:19], v[26:27] op_sel_hi:[1,0,1] neg_lo:[0,0,1] neg_hi:[0,0,1]
v_pk_fma_f32 v[32:33], v[30:31], v[18:19], v[28:29] op_sel_hi:[1,0,1] neg_lo:[0,0,1] neg_hi:[0,0,1]
v_pk_fma_f32 v[34:35], v[32:33], v[18:19], v[30:31] op_sel_hi:[1,0,1] neg_lo:[0,0,1] neg_hi:[0,0,1]
v_pk_fma_f32 v[36:37], v[34:35], v[18:19], v[32:33] op_sel_hi:[1,0,1] neg_lo:[0,0,1] neg_hi:[0,0,1]
v_pk_fma_f32 v[38:39], v[36:37], v[18:19], v[34:35] op_sel_hi:[1,0,1] neg_lo:[0,0,1] neg_hi:[0,0,1]
v_cvt_pk_bf16_f32 v60, v24, v26
v_cvt_pk_bf16_f32 v76, v25, v27
v_cvt_pk_bf16_f32 v61, v28, v30
v_cvt_pk_bf16_f32 v77, v29, v31
v_cvt_pk_bf16_f32 v62, v32, v34
v_cvt_pk_bf16_f32 v78, v33, v35
v_cvt_pk_bf16_f32 v63, v36, v38
v_cvt_pk_bf16_f32 v79, v37, v39
v_cos_f32 v24, v17
v_sin_f32 v25, v17
v_add_f32 v17, v17, v16
v_cos_f32 v26, v17
v_sin_f32 v27, v17
v_add_f32 v17, v17, v20
v_pk_fma_f32 v[28:29], v[26:27], v[18:19], v[24:25] op_sel_hi:[1,0,1] neg_lo:[0,0,1] neg_hi:[0,0,1]
v_pk_fma_f32 v[30:31], v[28:29], v[18:19], v[26:27] op_sel_hi:[1,0,1] neg_lo:[0,0,1] neg_hi:[0,0,1]
v_pk_fma_f32 v[32:33], v[30:31], v[18:19], v[28:29] op_sel_hi:[1,0,1] neg_lo:[0,0,1] neg_hi:[0,0,1]
v_pk_fma_f32 v[34:35], v[32:33], v[18:19], v[30:31] op_sel_hi:[1,0,1] neg_lo:[0,0,1] neg_hi:[0,0,1]
v_pk_fma_f32 v[36:37], v[34:35], v[18:19], v[32:33] op_sel_hi:[1,0,1] neg_lo:[0,0,1] neg_hi:[0,0,1]
v_pk_fma_f32 v[38:39], v[36:37], v[18:19], v[34:35] op_sel_hi:[1,0,1] neg_lo:[0,0,1] neg_hi:[0,0,1]
v_cvt_pk_bf16_f32 v64, v24, v26
v_cvt_pk_bf16_f32 v80, v25, v27
v_cvt_pk_bf16_f32 v65, v28, v30
v_cvt_pk_bf16_f32 v81, v29, v31
v_cvt_pk_bf16_f32 v66, v32, v34
v_cvt_pk_bf16_f32 v82, v33, v35
v_cvt_pk_bf16_f32 v67, v36, v38
v_cvt_pk_bf16_f32 v83, v37, v39
v_cos_f32 v24, v17
v_sin_f32 v25, v17
v_add_f32 v17, v17, v16
v_cos_f32 v26, v17
v_sin_f32 v27, v17
v_add_f32 v17, v17, v20
v_pk_fma_f32 v[28:29], v[26:27], v[18:19], v[24:25] op_sel_hi:[1,0,1] neg_lo:[0,0,1] neg_hi:[0,0,1]
v_pk_fma_f32 v[30:31], v[28:29], v[18:19], v[26:27] op_sel_hi:[1,0,1] neg_lo:[0,0,1] neg_hi:[0,0,1]
v_pk_fma_f32 v[32:33], v[30:31], v[18:19], v[28:29] op_sel_hi:[1,0,1] neg_lo:[0,0,1] neg_hi:[0,0,1]
v_pk_fma_f32 v[34:35], v[32:33], v[18:19], v[30:31] op_sel_hi:[1,0,1] neg_lo:[0,0,1] neg_hi:[0,0,1]
v_pk_fma_f32 v[36:37], v[34:35], v[18:19], v[32:33] op_sel_hi:[1,0,1] neg_lo:[0,0,1] neg_hi:[0,0,1]
v_pk_fma_f32 v[38:39], v[36:37], v[18:19], v[34:35] op_sel_hi:[1,0,1] neg_lo:[0,0,1] neg_hi:[0,0,1]
v_cvt_pk_bf16_f32 v68, v24, v26
v_cvt_pk_bf16_f32 v84, v25, v27
v_cvt_pk_bf16_f32 v69, v28, v30
v_cvt_pk_bf16_f32 v85, v29, v31
v_cvt_pk_bf16_f32 v70, v32, v34
v_cvt_pk_bf16_f32 v86, v33, v35
v_cvt_pk_bf16_f32 v71, v36, v38
v_cvt_pk_bf16_f32 v87, v37, v39
v_lshrrev_b32 v4, 1, v0
v_and_b32 v5, 1, v0
v_lshlrev_b32 v120, 7, v4
v_lshl_add_u32 v120, v5, 4, v120
v_add_u32 v120, 65536, v120
v_lshlrev_b32 v121, 4, v0
v_lshrrev_b32 v4, 2, v3
v_lshl_add_u32 v4, v2, 3, v4
v_lshlrev_b32 v122, 5, v4
v_and_b32 v5, 1, v0
v_lshl_add_u32 v122, v5, 3, v122
s_lshl_b32 s56, s3, 6
v_lshl_add_u32 v4, v6, 3, s56
v_and_b32 v5, 8, v0
v_lshl_add_u32 v4, v5, 5, v4
v_sub_u32 v5, 2040, v4
v_cmp_lt_u32 vcc, 31, v1
v_bfe_u32 v7, v0, 4, 1
s_nop 0
v_cndmask_b32 v124, v4, v5, vcc
v_lshl_add_u32 v124, v7, 2, v124
v_cndmask_b32_e64 v123, -1.0, 1.0, vcc
s_mov_b64 s[26:27], vcc
v_xor_b32 v128, 512, v124
v_add_u32 v125, 1, v124
v_add_u32 v129, 1, v128
v_add_u32 v126, 2, v124
v_add_u32 v130, 2, v128
v_add_u32 v127, 3, v124
v_add_u32 v131, 3, v128
v_and_b32 v132, 0xf0, v0
s_lshl_b32 s56, s3, 6
v_lshl_add_u32 v133, v3, 2, s56
v_lshlrev_b32 v134, 6, v2
v_and_b32 v136, 3, v0
v_lshlrev_b32 v136, 4, v136
v_lshrrev_b32 v135, 2, v1
v_lshl_add_u32 v135, v135, 7, v136
v_add_u32 v135, 2814976, v135
s_movk_i32 s59, 0x7ff
v_bfrev_b32 v140, 1
s_and_b32 s7, s2, 7
s_lshl_b32 s7, s7, 12
s_add_u32 s7, s7, 81920
v_lshl_add_u32 v4, v1, 7, s7
s_mov_b64 exec, 0xffff
global_load_dword v20, v4, s[40:41] offset:0 sc1
LW12:
s_waitcnt vmcnt(0)
LV12:
v_cmp_ne_u32 vcc, s6, v20
s_cbranch_vccnz LR12
LD12:
s_mov_b64 exec, -1
global_load_dwordx4 v[8:11], v120, s[40:41] sc1
LW13:
s_waitcnt vmcnt(0)
LV13:
v_max_u32 v16, v8, v9
v_max3_u32 v16, v16, v10, v11
v_cmp_eq_u32 vcc, -1, v16
s_cbranch_vccnz LR13
LD13:
s_mov_b64 exec, -1
ds_write_b128 v121, v[8:11]
v_lshl_add_u32 v4, v6, 7, s7
global_load_dword v142, v4, s[40:41] offset:3072 sc1
s_waitcnt lgkmcnt(0)
s_barrier
ds_read_b64_tr_b16 v[8:9], v122 offset:0
ds_read_b64_tr_b16 v[10:11], v122 offset:128
ds_read_b64_tr_b16 v[12:13], v122 offset:16
ds_read_b64_tr_b16 v[14:15], v122 offset:144
ds_read_b64_tr_b16 v[16:17], v122 offset:1024
ds_read_b64_tr_b16 v[18:19], v122 offset:1152
ds_read_b64_tr_b16 v[20:21], v122 offset:1040
ds_read_b64_tr_b16 v[22:23], v122 offset:1168
ds_read_b64_tr_b16 v[24:25], v122 offset:2048
ds_read_b64_tr_b16 v[26:27], v122 offset:2176
ds_read_b64_tr_b16 v[28:29], v122 offset:2064
ds_read_b64_tr_b16 v[30:31], v122 offset:2192
ds_read_b64_tr_b16 v[32:33], v122 offset:3072
ds_read_b64_tr_b16 v[34:35], v122 offset:3200
ds_read_b64_tr_b16 v[36:37], v122 offset:3088
ds_read_b64_tr_b16 v[38:39], v122 offset:3216
s_waitcnt lgkmcnt(14)
v_mfma_f32_16x16x32_bf16 v[144:147], v[8:11], v[56:59], 0
s_waitcnt lgkmcnt(12)
v_mfma_f32_16x16x32_bf16 v[148:151], v[12:15], v[72:75], 0
s_waitcnt lgkmcnt(10)
v_mfma_f32_16x16x32_bf16 v[144:147], v[16:19], v[60:63], v[144:147]
s_waitcnt lgkmcnt(8)
v_mfma_f32_16x16x32_bf16 v[148:151], v[20:23], v[76:79], v[148:151]
s_waitcnt lgkmcnt(6)
v_mfma_f32_16x16x32_bf16 v[144:147], v[24:27], v[64:67], v[144:147]
s_waitcnt lgkmcnt(4)
v_mfma_f32_16x16x32_bf16 v[148:151], v[28:31], v[80:83], v[148:151]
s_waitcnt lgkmcnt(2)
v_mfma_f32_16x16x32_bf16 v[144:147], v[32:35], v[68:71], v[144:147]
s_waitcnt lgkmcnt(0)
v_mfma_f32_16x16x32_bf16 v[148:151], v[36:39], v[84:87], v[148:151]
v_mfma_f32_16x16x32_bf16 v[152:155], v[8:11], v[88:91], 0
v_mfma_f32_16x16x32_bf16 v[156:159], v[12:15], v[104:107], 0
v_mfma_f32_16x16x32_bf16 v[152:155], v[16:19], v[92:95], v[152:155]
v_mfma_f32_16x16x32_bf16 v[156:159], v[20:23], v[108:111], v[156:159]
v_mfma_f32_16x16x32_bf16 v[152:155], v[24:27], v[96:99], v[152:155]
v_mfma_f32_16x16x32_bf16 v[156:159], v[28:31], v[112:115], v[156:159]
v_mfma_f32_16x16x32_bf16 v[152:155], v[32:35], v[100:103], v[152:155]
v_mfma_f32_16x16x32_bf16 v[156:159], v[36:39], v[116:119], v[156:159]
v_fmac_f32 v144, v148, v123
v_bfi_b32 v40, s59, v124, v144
v_fmac_f32 v145, v149, v123
v_bfi_b32 v41, s59, v125, v145
v_fmac_f32 v146, v150, v123
v_bfi_b32 v42, s59, v126, v146
v_fmac_f32 v147, v151, v123
v_bfi_b32 v43, s59, v127, v147
v_fmac_f32 v152, v156, v123
v_bfi_b32 v44, s59, v128, v152
v_fmac_f32 v153, v157, v123
v_bfi_b32 v45, s59, v129, v153
v_fmac_f32 v154, v158, v123
v_bfi_b32 v46, s59, v130, v154
v_fmac_f32 v155, v159, v123
v_bfi_b32 v47, s59, v131, v155
v_max3_i32 v8, v40, v41, v42
v_med3_i32 v9, v40, v41, v42
v_max3_i32 v10, v43, v44, v45
v_med3_i32 v11, v43, v44, v45
v_max_i32 v12, v46, v47
v_min_i32 v13, v46, v47
v_max3_i32 v48, v8, v10, v12
v_med3_i32 v49, v8, v10, v12
v_max3_i32 v9, v9, v11, v13
v_max_i32 v49, v49, v9
v_mov_b32_dpp v8, v48 row_ror:8 row_mask:0xf bank_mask:0xf
s_nop 0
v_max_i32_dpp v9, v49, v49 row_ror:8 row_mask:0xf bank_mask:0xf
v_max_i32 v10, v48, v8
v_med3_i32 v11, v48, v8, v9
s_nop 0
v_mov_b32_dpp v8, v10 row_ror:4 row_mask:0xf bank_mask:0xf
v_max_i32_dpp v9, v11, v11 row_ror:4 row_mask:0xf bank_mask:0xf
v_max_i32 v52, v10, v8
v_med3_i32 v53, v10, v8, v9
s_nop 0
v_mov_b32_dpp v8, v52 row_ror:2 row_mask:0xf bank_mask:0xf
v_max_i32_dpp v9, v53, v53 row_ror:2 row_mask:0xf bank_mask:0xf
v_max_i32 v10, v52, v8
v_med3_i32 v11, v52, v8, v9
s_nop 0
v_mov_b32_dpp v8, v10 row_ror:1 row_mask:0xf bank_mask:0xf
v_max_i32_dpp v9, v11, v11 row_ror:1 row_mask:0xf bank_mask:0xf
v_max_i32 v52, v10, v8
v_med3_i32 v53, v10, v8, v9
v_cmp_le_i32 vcc, v53, v48
v_cmp_le_i32_e64 s[16:17], v53, v49
s_nop 0
v_cndmask_b32 v48, v48, v49, vcc
v_cndmask_b32 v49, v49, v140, vcc
v_cndmask_b32_e64 v48, v48, v140, s[16:17]
s_nop 1
v_mov_b32_dpp v8, v48 row_ror:8 row_mask:0xf bank_mask:0xf
v_max_i32_dpp v9, v49, v49 row_ror:8 row_mask:0xf bank_mask:0xf
v_max_i32 v10, v48, v8
v_med3_i32 v11, v48, v8, v9
s_nop 0
v_mov_b32_dpp v8, v10 row_ror:4 row_mask:0xf bank_mask:0xf
v_max_i32_dpp v9, v11, v11 row_ror:4 row_mask:0xf bank_mask:0xf
v_max_i32 v54, v10, v8
v_med3_i32 v55, v10, v8, v9
s_nop 0
v_mov_b32_dpp v8, v54 row_ror:2 row_mask:0xf bank_mask:0xf
v_max_i32_dpp v9, v55, v55 row_ror:2 row_mask:0xf bank_mask:0xf
v_max_i32 v10, v54, v8
v_med3_i32 v11, v54, v8, v9
s_nop 0
v_mov_b32_dpp v8, v10 row_ror:1 row_mask:0xf bank_mask:0xf
v_max_i32_dpp v9, v11, v11 row_ror:1 row_mask:0xf bank_mask:0xf
v_max_i32 v54, v10, v8
v_med3_i32 v55, v10, v8, v9
ds_write_b128 v132, v[52:55] offset:8192
s_waitcnt lgkmcnt(0)
s_barrier
ds_read_b32 v32, v133 offset:8192
ds_read_b128 v[8:11], v134 offset:8192
ds_read_b128 v[12:15], v134 offset:8208
ds_read_b128 v[16:19], v134 offset:8224
ds_read_b128 v[20:23], v134 offset:8240
v_mov_b32 v33, 0
v_mov_b32 v34, 0
s_waitcnt lgkmcnt(3)
v_cmp_gt_i32_e64 s[16:17], v8, v32
v_cmp_gt_i32_e64 s[18:19], v9, v32
v_cmp_gt_i32_e64 s[20:21], v10, v32
v_cmp_gt_i32_e64 s[22:23], v11, v32
v_addc_co_u32_e64 v33, s[24:25], 0, v33, s[16:17]
v_addc_co_u32_e64 v34, s[24:25], 0, v34, s[18:19]
v_addc_co_u32_e64 v33, s[24:25], 0, v33, s[20:21]
v_addc_co_u32_e64 v34, s[24:25], 0, v34, s[22:23]
s_waitcnt lgkmcnt(2)
v_cmp_gt_i32_e64 s[16:17], v12, v32
v_cmp_gt_i32_e64 s[18:19], v13, v32
v_cmp_gt_i32_e64 s[20:21], v14, v32
v_cmp_gt_i32_e64 s[22:23], v15, v32
v_addc_co_u32_e64 v33, s[24:25], 0, v33, s[16:17]
v_addc_co_u32_e64 v34, s[24:25], 0, v34, s[18:19]
v_addc_co_u32_e64 v33, s[24:25], 0, v33, s[20:21]
v_addc_co_u32_e64 v34, s[24:25], 0, v34, s[22:23]
s_waitcnt lgkmcnt(1)
v_cmp_gt_i32_e64 s[16:17], v16, v32
v_cmp_gt_i32_e64 s[18:19], v17, v32
v_cmp_gt_i32_e64 s[20:21], v18, v32
v_cmp_gt_i32_e64 s[22:23], v19, v32
v_addc_co_u32_e64 v33, s[24:25], 0, v33, s[16:17]
v_addc_co_u32_e64 v34, s[24:25], 0, v34, s[18:19]
v_addc_co_u32_e64 v33, s[24:25], 0, v33, s[20:21]
v_addc_co_u32_e64 v34, s[24:25], 0, v34, s[22:23]
s_waitcnt lgkmcnt(0)
v_cmp_gt_i32_e64 s[16:17], v20, v32
v_cmp_gt_i32_e64 s[18:19], v21, v32
v_cmp_gt_i32_e64 s[20:21], v22, v32
v_cmp_gt_i32_e64 s[22:23], v23, v32
v_addc_co_u32_e64 v33, s[24:25], 0, v33, s[16:17]
v_addc_co_u32_e64 v34, s[24:25], 0, v34, s[18:19]
v_addc_co_u32_e64 v33, s[24:25], 0, v33, s[20:21]
v_addc_co_u32_e64 v34, s[24:25], 0, v34, s[22:23]
v_add_u32 v33, v33, v34
v_mov_b32 v34, v33
v_and_b32 v32, 0x7ff, v32
s_nop 0
v_permlane32_swap_b32 v33, v34
v_add_u32 v33, v33, v34
v_mov_b32 v34, v33
s_nop 1
v_permlane16_swap_b32 v33, v34
v_add_u32 v33, v33, v34
v_lshlrev_b32 v33, 2, v33
ds_write_b32 v33, v32 offset:8448
s_waitcnt lgkmcnt(0)
s_barrier
s_cmp_lg_u32 s3, 0
s_cbranch_scc1 L_fin
ds_read_b128 v[8:11], v136 offset:8448
s_waitcnt vmcnt(0)
v_cmp_ne_u32 vcc, s6, v142
s_cbranch_vccz L_sg
s_and_b32 s7, s2, 7
s_lshl_b32 s7, s7, 12
s_add_u32 s7, s7, 81920
v_lshl_add_u32 v4, v1, 7, s7
s_mov_b64 exec, 0xff
global_load_dword v20, v4, s[40:41] offset:3072 sc1
LW14:
s_waitcnt vmcnt(0)
LV14:
v_cmp_ne_u32 vcc, s6, v20
s_cbranch_vccnz LR14
LD14:
s_mov_b64 exec, -1
L_sg:
s_waitcnt lgkmcnt(0)
global_store_dwordx4 v135, v[8:11], s[40:41] sc1
s_branch L_fin
L_fx:
s_branch L_f2
L_f1:
s_setprio 0
s_sub_u32 s49, s14, 160
s_and_b32 s50, s49, 7
s_lshr_b32 s56, s49, 4
s_lshl3_add_u32 s50, s56, s50
s_lshl1_add_u32 s50, s50, s5
s_cmp_ge_u32 s49, 48
s_cselect_b32 s50, s49, s50
s_mul_i32 s56, s3, 80
s_lshl_b32 s57, s50, 6
v_lshrrev_b32 v4, 2, v1
v_mul_u32_u24 v6, 80, v4
v_add_u32 v4, s56, v4
v_and_b32 v5, 3, v0
v_lshl_add_u32 v7, v5, 4, s57
s_movk_i32 s56, 3456
v_add_u32 v5, 0, v4
v_lshrrev_b32 v13, 5, v5
v_and_b32 v5, 31, v5
v_mad_u32_u24 v5, v5, 20, v13
v_mad_u32_u24 v8, v5, s56, v7
v_add_u32 v5, 16, v4
v_lshrrev_b32 v13, 5, v5
v_and_b32 v5, 31, v5
v_mad_u32_u24 v5, v5, 20, v13
v_mad_u32_u24 v9, v5, s56, v7
v_add_u32 v5, 32, v4
v_lshrrev_b32 v13, 5, v5
v_and_b32 v5, 31, v5
v_mad_u32_u24 v5, v5, 20, v13
v_mad_u32_u24 v10, v5, s56, v7
v_add_u32 v5, 48, v4
v_lshrrev_b32 v13, 5, v5
v_and_b32 v5, 31, v5
v_mad_u32_u24 v5, v5, 20, v13
v_mad_u32_u24 v11, v5, s56, v7
v_add_u32 v5, 64, v4
v_lshrrev_b32 v13, 5, v5
v_and_b32 v5, 31, v5
v_mad_u32_u24 v5, v5, 20, v13
v_mad_u32_u24 v12, v5, s56, v7
s_mul_i32 s58, s3, 5120
s_add_u32 s59, s58, 40992
s_bitcmp1_b32 s50, 0
s_cselect_b64 s[8:9], s[32:33], s[30:31]
s_cselect_b64 s[10:11], s[30:31], s[32:33]
s_cselect_b32 s60, s59, s58
s_cselect_b32 s61, s58, s59
s_add_u32 m0, s60, 0
s_nop 0
global_load_lds_dwordx4 v8, s[8:9]
s_waitcnt vmcnt(1)
s_barrier
s_barrier
s_add_u32 m0, s60, 1024
s_nop 0
global_load_lds_dwordx4 v9, s[8:9]
s_add_u32 m0, s60, 2048
s_nop 0
global_load_lds_dwordx4 v10, s[8:9]
s_add_u32 m0, s60, 3072
s_nop 0
global_load_lds_dwordx4 v11, s[8:9]
s_add_u32 m0, s60, 4096
s_nop 0
global_load_lds_dwordx4 v12, s[8:9]
s_add_u32 m0, s61, 0
s_nop 0
global_load_lds_dwordx4 v8, s[10:11]
s_add_u32 m0, s61, 1024
s_nop 0
global_load_lds_dwordx4 v9, s[10:11]
s_add_u32 m0, s61, 2048
s_nop 0
global_load_lds_dwordx4 v10, s[10:11]
s_add_u32 m0, s61, 3072
s_nop 0
global_load_lds_dwordx4 v11, s[10:11]
s_add_u32 m0, s61, 4096
s_nop 0
global_load_lds_dwordx4 v12, s[10:11]
v_add_u32 v89, 105088, v6
v_lshlrev_b32 v161, 4, v3
v_add_u32 v161, 2819072, v161
s_mov_b32 s22, 0x3acccccd
v_mov_b32 v158, 0x3727c5ac
v_add_u32 v160, 2760704, v157
s_mul_i32 s16, s3, 3072
v_add_u32 v162, s16, v160
s_add_u32 s17, s16, 82048
s_mov_b64 s[20:21], 0xffff
v_mul_u32_u24 v165, 1312, v3
v_lshl_add_u32 v165, v2, 4, v165
v_add_u32 v165, 82048, v165
s_lshl2_add_u32 s16, s50, s3
s_lshl_b32 s16, s16, 7
s_add_u32 s16, s16, 2823680
v_and_b32 v164, 7, v0
v_lshl_add_u32 v164, v164, 4, s16
v_lshrrev_b32 v166, 3, v3
v_mul_u32_u24 v166, 27648, v166
v_add_u32 v164, v164, v166
v_and_b32 v166, 1, v2
v_lshl_add_u32 v164, v166, 3, v164
v_lshrrev_b32 v166, 1, v2
v_lshl_add_u32 v164, v166, 2, v164
s_lshl_b32 s16, s49, 7
s_add_u32 s16, s16, 2819584
v_mov_b32 v167, s16
v_mov_b32 v159, 139264
s_mov_b32 s62, 0
v_and_b32 v4, 1, v0
v_lshlrev_b32 v4, 3, v4
v_bfe_u32 v5, v0, 1, 1
v_mul_u32_u24 v5, 40992, v5
s_lshl_b32 s56, s3, 4
v_add3_u32 v7, v4, v5, s56
s_waitcnt vmcnt(0)
s_barrier
s_cmp_ge_u32 s3, 4
s_cbranch_scc1 L_f1w
ds_read_b128 v[104:107], v89 offset:0
ds_read_b128 v[108:111], v89 offset:16
ds_read_b128 v[112:115], v89 offset:32
ds_read_b128 v[116:119], v89 offset:48
ds_read_b128 v[120:123], v89 offset:64
s_waitcnt lgkmcnt(0)
v_add_u32_sdwa v4, v104, v7 dst_sel:DWORD dst_unused:UNUSED_PAD src0_sel:WORD_0 src1_sel:DWORD
v_add_u32_sdwa v5, v104, v7 dst_sel:DWORD dst_unused:UNUSED_PAD src0_sel:WORD_1 src1_sel:DWORD
ds_read_b64_tr_b16 v[8:9], v4
ds_read_b64_tr_b16 v[10:11], v5
v_add_u32_sdwa v4, v105, v7 dst_sel:DWORD dst_unused:UNUSED_PAD src0_sel:WORD_0 src1_sel:DWORD
v_add_u32_sdwa v5, v105, v7 dst_sel:DWORD dst_unused:UNUSED_PAD src0_sel:WORD_1 src1_sel:DWORD
ds_read_b64_tr_b16 v[12:13], v4
ds_read_b64_tr_b16 v[14:15], v5
v_add_u32_sdwa v4, v106, v7 dst_sel:DWORD dst_unused:UNUSED_PAD src0_sel:WORD_0 src1_sel:DWORD
v_add_u32_sdwa v5, v106, v7 dst_sel:DWORD dst_unused:UNUSED_PAD src0_sel:WORD_1 src1_sel:DWORD
ds_read_b64_tr_b16 v[16:17], v4
ds_read_b64_tr_b16 v[18:19], v5
v_add_u32_sdwa v4, v107, v7 dst_sel:DWORD dst_unused:UNUSED_PAD src0_sel:WORD_0 src1_sel:DWORD
v_add_u32_sdwa v5, v107, v7 dst_sel:DWORD dst_unused:UNUSED_PAD src0_sel:WORD_1 src1_sel:DWORD
ds_read_b64_tr_b16 v[20:21], v4
ds_read_b64_tr_b16 v[22:23], v5
v_add_u32_sdwa v4, v108, v7 dst_sel:DWORD dst_unused:UNUSED_PAD src0_sel:WORD_0 src1_sel:DWORD
v_add_u32_sdwa v5, v108, v7 dst_sel:DWORD dst_unused:UNUSED_PAD src0_sel:WORD_1 src1_sel:DWORD
ds_read_b64_tr_b16 v[24:25], v4
ds_read_b64_tr_b16 v[26:27], v5
v_add_u32_sdwa v4, v109, v7 dst_sel:DWORD dst_unused:UNUSED_PAD src0_sel:WORD_0 src1_sel:DWORD
v_add_u32_sdwa v5, v109, v7 dst_sel:DWORD dst_unused:UNUSED_PAD src0_sel:WORD_1 src1_sel:DWORD
ds_read_b64_tr_b16 v[28:29], v4
ds_read_b64_tr_b16 v[30:31], v5
v_add_u32_sdwa v4, v110, v7 dst_sel:DWORD dst_unused:UNUSED_PAD src0_sel:WORD_0 src1_sel:DWORD
v_add_u32_sdwa v5, v110, v7 dst_sel:DWORD dst_unused:UNUSED_PAD src0_sel:WORD_1 src1_sel:DWORD
ds_read_b64_tr_b16 v[32:33], v4
ds_read_b64_tr_b16 v[34:35], v5
v_add_u32_sdwa v4, v111, v7 dst_sel:DWORD dst_unused:UNUSED_PAD src0_sel:WORD_0 src1_sel:DWORD
v_add_u32_sdwa v5, v111, v7 dst_sel:DWORD dst_unused:UNUSED_PAD src0_sel:WORD_1 src1_sel:DWORD
ds_read_b64_tr_b16 v[36:37], v4
ds_read_b64_tr_b16 v[38:39], v5
v_add_u32_sdwa v4, v112, v7 dst_sel:DWORD dst_unused:UNUSED_PAD src0_sel:WORD_0 src1_sel:DWORD
v_add_u32_sdwa v5, v112, v7 dst_sel:DWORD dst_unused:UNUSED_PAD src0_sel:WORD_1 src1_sel:DWORD
ds_read_b64_tr_b16 v[40:41], v4
ds_read_b64_tr_b16 v[42:43], v5
v_add_u32_sdwa v4, v113, v7 dst_sel:DWORD dst_unused:UNUSED_PAD src0_sel:WORD_0 src1_sel:DWORD
v_add_u32_sdwa v5, v113, v7 dst_sel:DWORD dst_unused:UNUSED_PAD src0_sel:WORD_1 src1_sel:DWORD
ds_read_b64_tr_b16 v[44:45], v4
ds_read_b64_tr_b16 v[46:47], v5
v_add_u32_sdwa v4, v114, v7 dst_sel:DWORD dst_unused:UNUSED_PAD src0_sel:WORD_0 src1_sel:DWORD
v_add_u32_sdwa v5, v114, v7 dst_sel:DWORD dst_unused:UNUSED_PAD src0_sel:WORD_1 src1_sel:DWORD
ds_read_b64_tr_b16 v[48:49], v4
ds_read_b64_tr_b16 v[50:51], v5
v_add_u32_sdwa v4, v115, v7 dst_sel:DWORD dst_unused:UNUSED_PAD src0_sel:WORD_0 src1_sel:DWORD
v_add_u32_sdwa v5, v115, v7 dst_sel:DWORD dst_unused:UNUSED_PAD src0_sel:WORD_1 src1_sel:DWORD
ds_read_b64_tr_b16 v[52:53], v4
ds_read_b64_tr_b16 v[54:55], v5
v_add_u32_sdwa v4, v116, v7 dst_sel:DWORD dst_unused:UNUSED_PAD src0_sel:WORD_0 src1_sel:DWORD
v_add_u32_sdwa v5, v116, v7 dst_sel:DWORD dst_unused:UNUSED_PAD src0_sel:WORD_1 src1_sel:DWORD
ds_read_b64_tr_b16 v[56:57], v4
ds_read_b64_tr_b16 v[58:59], v5
v_add_u32_sdwa v4, v117, v7 dst_sel:DWORD dst_unused:UNUSED_PAD src0_sel:WORD_0 src1_sel:DWORD
v_add_u32_sdwa v5, v117, v7 dst_sel:DWORD dst_unused:UNUSED_PAD src0_sel:WORD_1 src1_sel:DWORD
ds_read_b64_tr_b16 v[60:61], v4
ds_read_b64_tr_b16 v[62:63], v5
v_add_u32_sdwa v4, v118, v7 dst_sel:DWORD dst_unused:UNUSED_PAD src0_sel:WORD_0 src1_sel:DWORD
v_add_u32_sdwa v5, v118, v7 dst_sel:DWORD dst_unused:UNUSED_PAD src0_sel:WORD_1 src1_sel:DWORD
ds_read_b64_tr_b16 v[64:65], v4
ds_read_b64_tr_b16 v[66:67], v5
v_add_u32_sdwa v4, v119, v7 dst_sel:DWORD dst_unused:UNUSED_PAD src0_sel:WORD_0 src1_sel:DWORD
v_add_u32_sdwa v5, v119, v7 dst_sel:DWORD dst_unused:UNUSED_PAD src0_sel:WORD_1 src1_sel:DWORD
ds_read_b64_tr_b16 v[68:69], v4
ds_read_b64_tr_b16 v[70:71], v5
v_add_u32_sdwa v4, v120, v7 dst_sel:DWORD dst_unused:UNUSED_PAD src0_sel:WORD_0 src1_sel:DWORD
v_add_u32_sdwa v5, v120, v7 dst_sel:DWORD dst_unused:UNUSED_PAD src0_sel:WORD_1 src1_sel:DWORD
ds_read_b64_tr_b16 v[72:73], v4
ds_read_b64_tr_b16 v[74:75], v5
v_add_u32_sdwa v4, v121, v7 dst_sel:DWORD dst_unused:UNUSED_PAD src0_sel:WORD_0 src1_sel:DWORD
v_add_u32_sdwa v5, v121, v7 dst_sel:DWORD dst_unused:UNUSED_PAD src0_sel:WORD_1 src1_sel:DWORD
ds_read_b64_tr_b16 v[76:77], v4
ds_read_b64_tr_b16 v[78:79], v5
v_add_u32_sdwa v4, v122, v7 dst_sel:DWORD dst_unused:UNUSED_PAD src0_sel:WORD_0 src1_sel:DWORD
v_add_u32_sdwa v5, v122, v7 dst_sel:DWORD dst_unused:UNUSED_PAD src0_sel:WORD_1 src1_sel:DWORD
ds_read_b64_tr_b16 v[80:81], v4
ds_read_b64_tr_b16 v[82:83], v5
v_add_u32_sdwa v4, v123, v7 dst_sel:DWORD dst_unused:UNUSED_PAD src0_sel:WORD_0 src1_sel:DWORD
v_add_u32_sdwa v5, v123, v7 dst_sel:DWORD dst_unused:UNUSED_PAD src0_sel:WORD_1 src1_sel:DWORD
ds_read_b64_tr_b16 v[84:85], v4
ds_read_b64_tr_b16 v[86:87], v5
s_waitcnt lgkmcnt(0)
L_f1w:
s_barrier
L_f1p:
s_cmp_eq_u32 s3, 7
s_cbranch_scc1 L_f1h
s_mov_b32 m0, s17
s_nop 0
global_load_lds_dwordx4 v162, s[40:41] offset:0 sc1
global_load_lds_dwordx4 v162, s[40:41] offset:1024 sc1
global_load_lds_dwordx4 v162, s[40:41] offset:2048 sc1
s_cmp_ge_u32 s3, 4
s_cbranch_scc1 L_f1r
global_load_dwordx2 v[150:151], v161, s[40:41] sc1
v_mov_b32 v88, 0x3f803f80
v_mov_b32 v89, 0x3f803f80
v_mov_b32 v90, 0x3f803f80
v_mov_b32 v91, 0x3f803f80
s_nop 1
v_mfma_f32_16x16x32_bf16 v[152:155], v[8:11], v[88:91], 0
v_mfma_f32_16x16x32_bf16 v[152:155], v[12:15], v[88:91], v[152:155]
v_mfma_f32_16x16x32_bf16 v[152:155], v[16:19], v[88:91], v[152:155]
v_mfma_f32_16x16x32_bf16 v[152:155], v[20:23], v[88:91], v[152:155]
v_mfma_f32_16x16x32_bf16 v[152:155], v[24:27], v[88:91], v[152:155]
v_mfma_f32_16x16x32_bf16 v[152:155], v[28:31], v[88:91], v[152:155]
v_mfma_f32_16x16x32_bf16 v[152:155], v[32:35], v[88:91], v[152:155]
v_mfma_f32_16x16x32_bf16 v[152:155], v[36:39], v[88:91], v[152:155]
v_mfma_f32_16x16x32_bf16 v[152:155], v[40:43], v[88:91], v[152:155]
v_mfma_f32_16x16x32_bf16 v[152:155], v[44:47], v[88:91], v[152:155]
v_mfma_f32_16x16x32_bf16 v[152:155], v[48:51], v[88:91], v[152:155]
v_mfma_f32_16x16x32_bf16 v[152:155], v[52:55], v[88:91], v[152:155]
v_mfma_f32_16x16x32_bf16 v[152:155], v[56:59], v[88:91], v[152:155]
v_mfma_f32_16x16x32_bf16 v[152:155], v[60:63], v[88:91], v[152:155]
v_mfma_f32_16x16x32_bf16 v[152:155], v[64:67], v[88:91], v[152:155]
v_mfma_f32_16x16x32_bf16 v[152:155], v[68:71], v[88:91], v[152:155]
v_mfma_f32_16x16x32_bf16 v[152:155], v[72:75], v[88:91], v[152:155]
v_mfma_f32_16x16x32_bf16 v[152:155], v[76:79], v[88:91], v[152:155]
v_mfma_f32_16x16x32_bf16 v[152:155], v[80:83], v[88:91], v[152:155]
v_mfma_f32_16x16x32_bf16 v[152:155], v[84:87], v[88:91], v[152:155]
L_f1r:
s_waitcnt vmcnt(0)
L_f1q:
s_barrier
s_cmp_lt_u32 s3, 4
s_cbranch_scc1 L_p4
s_cmp_lg_u32 s3, 7
s_cbranch_scc1 L_p4e
s_cmp_ge_u32 s49, 8
s_cbranch_scc1 L_p4e
s_branch L_p4e
L_p4:
ds_read_b128 v[92:95], v165 offset:0
ds_read_b128 v[96:99], v165 offset:64
ds_read_b128 v[100:103], v165 offset:128
ds_read_b128 v[104:107], v165 offset:192
v_cmp_u_f32 vcc, v150, v151
v_mul_f32 v88, s22, v150
ds_read_b128 v[108:111], v165 offset:256
ds_read_b128 v[112:115], v165 offset:320
ds_read_b128 v[116:119], v165 offset:384
ds_read_b128 v[120:123], v165 offset:448
ds_read_b128 v[124:127], v165 offset:512
ds_read_b128 v[128:131], v165 offset:576
ds_read_b128 v[132:135], v165 offset:640
ds_read_b128 v[136:139], v165 offset:704
s_waitcnt lgkmcnt(11)
v_mfma_f32_16x16x32_bf16 v[144:147], v[8:11], v[92:95], 0
s_waitcnt lgkmcnt(10)
v_mfma_f32_16x16x32_bf16 v[144:147], v[12:15], v[96:99], v[144:147]
ds_read_b128 v[140:143], v165 offset:768
s_waitcnt lgkmcnt(10)
v_mfma_f32_16x16x32_bf16 v[144:147], v[16:19], v[100:103], v[144:147]
ds_read_b128 v[92:95], v165 offset:832
s_waitcnt lgkmcnt(10)
v_mfma_f32_16x16x32_bf16 v[144:147], v[20:23], v[104:107], v[144:147]
ds_read_b128 v[96:99], v165 offset:896
s_waitcnt lgkmcnt(10)
v_mfma_f32_16x16x32_bf16 v[144:147], v[24:27], v[108:111], v[144:147]
ds_read_b128 v[100:103], v165 offset:960
s_waitcnt lgkmcnt(10)
v_mfma_f32_16x16x32_bf16 v[144:147], v[28:31], v[112:115], v[144:147]
ds_read_b128 v[104:107], v165 offset:1024
s_waitcnt lgkmcnt(10)
v_mfma_f32_16x16x32_bf16 v[144:147], v[32:35], v[116:119], v[144:147]
ds_read_b128 v[108:111], v165 offset:1088
s_waitcnt lgkmcnt(10)
v_mfma_f32_16x16x32_bf16 v[144:147], v[36:39], v[120:123], v[144:147]
ds_read_b128 v[112:115], v165 offset:1152
s_waitcnt lgkmcnt(10)
v_mfma_f32_16x16x32_bf16 v[144:147], v[40:43], v[124:127], v[144:147]
ds_read_b128 v[116:119], v165 offset:1216
s_waitcnt lgkmcnt(10)
v_mfma_f32_16x16x32_bf16 v[144:147], v[44:47], v[128:131], v[144:147]
s_waitcnt lgkmcnt(9)
v_mfma_f32_16x16x32_bf16 v[144:147], v[48:51], v[132:135], v[144:147]
v_fma_f32 v90, v151, s22, v158
s_waitcnt lgkmcnt(8)
v_mfma_f32_16x16x32_bf16 v[144:147], v[52:55], v[136:139], v[144:147]
v_fma_f32 v91, -v88, v88, v90
s_waitcnt lgkmcnt(7)
v_mfma_f32_16x16x32_bf16 v[144:147], v[56:59], v[140:143], v[144:147]
v_max_f32 v91, v91, v158
s_waitcnt lgkmcnt(6)
v_mfma_f32_16x16x32_bf16 v[144:147], v[60:63], v[92:95], v[144:147]
v_rsq_f32 v89, v91
s_waitcnt lgkmcnt(5)
v_mfma_f32_16x16x32_bf16 v[144:147], v[64:67], v[96:99], v[144:147]
v_rcp_f32 v91, v91
s_waitcnt lgkmcnt(4)
v_mfma_f32_16x16x32_bf16 v[144:147], v[68:71], v[100:103], v[144:147]
v_mul_f32 v89, 0xbfb8aa3b, v89
s_waitcnt lgkmcnt(3)
v_mfma_f32_16x16x32_bf16 v[144:147], v[72:75], v[104:107], v[144:147]
s_waitcnt lgkmcnt(2)
v_mfma_f32_16x16x32_bf16 v[144:147], v[76:79], v[108:111], v[144:147]
s_waitcnt lgkmcnt(1)
v_mfma_f32_16x16x32_bf16 v[144:147], v[80:83], v[112:115], v[144:147]
s_waitcnt lgkmcnt(0)
v_mfma_f32_16x16x32_bf16 v[144:147], v[84:87], v[116:119], v[144:147]
s_cbranch_vccnz L_st
L_std:
s_nop 6
v_pk_fma_f32 v[144:145], v[152:153], v[88:89], v[144:145] op_sel_hi:[1,0,1] neg_lo:[1,0,0] neg_hi:[1,0,0]
v_pk_fma_f32 v[146:147], v[154:155], v[88:89], v[146:147] op_sel_hi:[1,0,1] neg_lo:[1,0,0] neg_hi:[1,0,0]
s_nop 1
v_permlane32_swap_b32 v144, v146
v_permlane32_swap_b32 v145, v147
v_mul_f32 v148, v89, v144
v_mul_f32 v149, v89, v145
v_exp_f32 v148, v148
v_exp_f32 v149, v149
v_mul_f32 v144, v144, v146
v_mul_f32 v145, v145, v147
v_add_f32 v148, 1.0, v148
v_add_f32 v149, 1.0, v149
v_rcp_f32 v148, v148
v_rcp_f32 v149, v149
v_cmp_u_f32 vcc, v146, v90
v_mul_f32 v144, v144, v91
v_mul_f32 v145, v145, v91
v_mul_f32 v144, v144, v148
v_mul_f32 v145, v145, v149
v_cvt_pk_bf16_f32 v144, v144, v145
s_and_b64 vcc, vcc, s[20:21]
s_cbranch_vccnz L_p4r
L_p4s:
global_store_dword v164, v144, s[40:41] sc1
L_p4e:
s_cmp_lg_u32 s62, 0
s_cbranch_scc1 L_fin
s_barrier
ds_read_b32 v4, v159
s_waitcnt lgkmcnt(0)
v_readfirstlane_b32 s62, v4
s_nop 0
s_cmp_eq_u32 s62, 0
s_cbranch_scc1 L_fin
v_add_u32 v162, 21504, v162
v_add_u32 v160, 21504, v160
v_add_u32 v164, 55296, v164
v_and_b32 v4, 7, v0
v_mul_u32_u24 v165, 1312, v4
v_lshl_add_u32 v165, v2, 4, v165
v_add_u32 v165, 82048, v165
v_lshlrev_b32 v161, 4, v4
v_add_u32 v161, 2819328, v161
s_movk_i32 s20, 0xff
s_branch L_f1p
L_bf8:
s_cmp_lt_u32 s14, 216
s_cbranch_scc1 L_fin
L_f2:
s_sub_u32 s49, s14, 216
s_and_b32 s52, s49, 7
s_lshr_b32 s50, s49, 3
s_and_b32 s56, s49, 3
s_lshr_b32 s57, s49, 2
s_cmp_ge_u32 s49, 32
s_cselect_b32 s50, s56, s50
s_cselect_b32 s52, s57, s52
s_lshr_b32 s51, s50, 1
s_lshl1_add_u32 s51, s52, s51
s_lshl_b32 s51, s51, 6
s_and_b32 s53, s50, 1
v_mov_b32 v159, 139264
v_bfe_u32 v7, v0, 3, 1
s_cmp_ge_u32 s3, 8
s_cbranch_scc1 L_f2e
v_lshrrev_b32 v4, 2, v1
v_mul_u32_u24 v4, 1280, v4
v_and_b32 v5, 3, v0
v_lshl_add_u32 v4, v5, 4, v4
s_mul_i32 s56, s3, 81920
s_add_u32 s56, s56, s51
v_add_u32 v4, s56, v4
s_lshl_b32 s58, s3, 14
s_cmp_ge_u32 s3, 3
s_cselect_b32 s61, 2, 3
s_mov_b32 s62, 0
s_add_u32 s59, s50, 0
s_and_b32 s59, s59, 3
s_cmp_gt_u32 s59, s61
s_cbranch_scc1 L_f2s0
s_mul_i32 s60, s59, 655360
s_lshl_b32 s59, s59, 12
s_add_u32 m0, s59, s58
v_add_u32 v5, s60, v4
global_load_lds_dwordx4 v5, s[34:35]
s_add_u32 m0, m0, 1024
v_add_u32 v5, 20480, v5
global_load_lds_dwordx4 v5, s[34:35]
s_add_u32 m0, m0, 1024
v_add_u32 v5, 20480, v5
global_load_lds_dwordx4 v5, s[34:35]
s_add_u32 m0, m0, 1024
v_add_u32 v5, 20480, v5
global_load_lds_dwordx4 v5, s[34:35]
L_f2s0:
s_add_u32 s59, s50, 1
s_and_b32 s59, s59, 3
s_cmp_gt_u32 s59, s61
s_cbranch_scc1 L_f2s1
s_mul_i32 s60, s59, 655360
s_lshl_b32 s59, s59, 12
s_add_u32 m0, s59, s58
v_add_u32 v5, s60, v4
global_load_lds_dwordx4 v5, s[34:35]
s_add_u32 m0, m0, 1024
v_add_u32 v5, 20480, v5
global_load_lds_dwordx4 v5, s[34:35]
s_add_u32 m0, m0, 1024
v_add_u32 v5, 20480, v5
global_load_lds_dwordx4 v5, s[34:35]
s_add_u32 m0, m0, 1024
v_add_u32 v5, 20480, v5
global_load_lds_dwordx4 v5, s[34:35]
L_f2s1:
s_add_u32 s59, s50, 2
s_and_b32 s59, s59, 3
s_cmp_gt_u32 s59, s61
s_cbranch_scc1 L_f2s2
s_mul_i32 s60, s59, 655360
s_lshl_b32 s59, s59, 12
s_add_u32 m0, s59, s58
v_add_u32 v5, s60, v4
global_load_lds_dwordx4 v5, s[34:35]
s_add_u32 m0, m0, 1024
v_add_u32 v5, 20480, v5
global_load_lds_dwordx4 v5, s[34:35]
s_add_u32 m0, m0, 1024
v_add_u32 v5, 20480, v5
global_load_lds_dwordx4 v5, s[34:35]
s_add_u32 m0, m0, 1024
v_add_u32 v5, 20480, v5
global_load_lds_dwordx4 v5, s[34:35]
L_f2s2:
s_add_u32 s59, s50, 3
s_and_b32 s59, s59, 3
s_cmp_gt_u32 s59, s61
s_cbranch_scc1 L_f2s3
s_mul_i32 s60, s59, 655360
s_lshl_b32 s59, s59, 12
s_add_u32 m0, s59, s58
v_add_u32 v5, s60, v4
global_load_lds_dwordx4 v5, s[34:35]
s_add_u32 m0, m0, 1024
v_add_u32 v5, 20480, v5
global_load_lds_dwordx4 v5, s[34:35]
s_add_u32 m0, m0, 1024
v_add_u32 v5, 20480, v5
global_load_lds_dwordx4 v5, s[34:35]
s_add_u32 m0, m0, 1024
v_add_u32 v5, 20480, v5
global_load_lds_dwordx4 v5, s[34:35]
L_f2s3:
s_mul_i32 s17, s53, 27648
s_lshl_b32 s16, s3, 10
s_add_u32 s17, s17, s16
s_add_u32 s17, s17, 2823680
v_lshl_add_u32 v104, v6, 4, s17
v_lshl_add_u32 v104, v2, 7, v104
v_lshl_add_u32 v104, v7, 9, v104
v_add_u32 v105, 0x2000, v104
v_add_u32 v106, 0x4000, v104
s_lshl_b32 s61, s61, 13
v_add_u32 v107, s61, v104
s_add_u32 s16, s16, 131072
v_add_u32 v157, s16, v157
v_cmp_eq_u32_e64 s[20:21], 1, v7
v_lshrrev_b32 v4, 2, v3
v_lshl_add_u32 v4, v2, 3, v4
v_lshlrev_b32 v4, 6, v4
v_and_b32 v5, 3, v0
v_lshl_add_u32 v4, v5, 3, v4
v_add_u32 v4, s58, v4
s_waitcnt vmcnt(0)
ds_read_b64_tr_b16 v[8:9], v4 offset:0
ds_read_b64_tr_b16 v[10:11], v4 offset:256
ds_read_b64_tr_b16 v[12:13], v4 offset:32
ds_read_b64_tr_b16 v[14:15], v4 offset:288
ds_read_b64_tr_b16 v[16:17], v4 offset:2048
ds_read_b64_tr_b16 v[18:19], v4 offset:2304
ds_read_b64_tr_b16 v[20:21], v4 offset:2080
ds_read_b64_tr_b16 v[22:23], v4 offset:2336
ds_read_b64_tr_b16 v[24:25], v4 offset:4096
ds_read_b64_tr_b16 v[26:27], v4 offset:4352
ds_read_b64_tr_b16 v[28:29], v4 offset:4128
ds_read_b64_tr_b16 v[30:31], v4 offset:4384
ds_read_b64_tr_b16 v[32:33], v4 offset:6144
ds_read_b64_tr_b16 v[34:35], v4 offset:6400
ds_read_b64_tr_b16 v[36:37], v4 offset:6176
ds_read_b64_tr_b16 v[38:39], v4 offset:6432
ds_read_b64_tr_b16 v[40:41], v4 offset:8192
ds_read_b64_tr_b16 v[42:43], v4 offset:8448
ds_read_b64_tr_b16 v[44:45], v4 offset:8224
ds_read_b64_tr_b16 v[46:47], v4 offset:8480
ds_read_b64_tr_b16 v[48:49], v4 offset:10240
ds_read_b64_tr_b16 v[50:51], v4 offset:10496
ds_read_b64_tr_b16 v[52:53], v4 offset:10272
ds_read_b64_tr_b16 v[54:55], v4 offset:10528
ds_read_b64_tr_b16 v[56:57], v4 offset:12288
ds_read_b64_tr_b16 v[58:59], v4 offset:12544
ds_read_b64_tr_b16 v[60:61], v4 offset:12320
ds_read_b64_tr_b16 v[62:63], v4 offset:12576
ds_read_b64_tr_b16 v[64:65], v4 offset:14336
ds_read_b64_tr_b16 v[66:67], v4 offset:14592
ds_read_b64_tr_b16 v[68:69], v4 offset:14368
ds_read_b64_tr_b16 v[70:71], v4 offset:14624
s_waitcnt lgkmcnt(0)
s_cmp_lt_u32 s3, 3
s_cbranch_scc1 L_p5a
v_mov_b32 v56, 0
v_mov_b32 v57, 0
v_mov_b32 v58, 0
v_mov_b32 v59, 0
v_mov_b32 v60, 0
v_mov_b32 v61, 0
v_mov_b32 v62, 0
v_mov_b32 v63, 0
v_mov_b32 v64, 0
v_mov_b32 v65, 0
v_mov_b32 v66, 0
v_mov_b32 v67, 0
v_mov_b32 v68, 0
v_mov_b32 v69, 0
v_mov_b32 v70, 0
v_mov_b32 v71, 0
L_p5a:
s_barrier
s_barrier
L_f2p:
global_load_dwordx4 v[72:75], v104, s[40:41] sc1
global_load_dwordx4 v[76:79], v105, s[40:41] sc1
global_load_dwordx4 v[80:83], v106, s[40:41] sc1
global_load_dwordx4 v[84:87], v107, s[40:41] sc1
LW15:
s_mov_b64 exec, -1
s_waitcnt vmcnt(3)
v_mfma_f32_16x16x32_bf16 v[88:91], v[8:11], v[72:75], 0
v_mfma_f32_16x16x32_bf16 v[96:99], v[12:15], v[72:75], 0
v_max_u32 v114, v72, v73
v_max3_u32 v114, v114, v74, v75
v_mfma_f32_16x16x32_bf16 v[92:95], v[16:19], v[72:75], 0
v_mfma_f32_16x16x32_bf16 v[100:103], v[20:23], v[72:75], 0
s_waitcnt vmcnt(2)
v_mfma_f32_16x16x32_bf16 v[88:91], v[24:27], v[76:79], v[88:91]
v_mfma_f32_16x16x32_bf16 v[96:99], v[28:31], v[76:79], v[96:99]
v_max3_u32 v114, v114, v76, v77
v_max3_u32 v114, v114, v78, v79
v_mfma_f32_16x16x32_bf16 v[92:95], v[32:35], v[76:79], v[92:95]
v_mfma_f32_16x16x32_bf16 v[100:103], v[36:39], v[76:79], v[100:103]
s_waitcnt vmcnt(1)
v_mfma_f32_16x16x32_bf16 v[88:91], v[40:43], v[80:83], v[88:91]
v_mfma_f32_16x16x32_bf16 v[96:99], v[44:47], v[80:83], v[96:99]
v_max3_u32 v114, v114, v80, v81
v_max3_u32 v114, v114, v82, v83
v_mfma_f32_16x16x32_bf16 v[92:95], v[48:51], v[80:83], v[92:95]
v_mfma_f32_16x16x32_bf16 v[100:103], v[52:55], v[80:83], v[100:103]
s_waitcnt vmcnt(0)
v_mfma_f32_16x16x32_bf16 v[88:91], v[56:59], v[84:87], v[88:91]
v_mfma_f32_16x16x32_bf16 v[96:99], v[60:63], v[84:87], v[96:99]
v_max3_u32 v114, v114, v84, v85
v_max3_u32 v114, v114, v86, v87
v_mfma_f32_16x16x32_bf16 v[92:95], v[64:67], v[84:87], v[92:95]
v_mfma_f32_16x16x32_bf16 v[100:103], v[68:71], v[84:87], v[100:103]
v_cmp_eq_u32 vcc, -1, v114
s_cbranch_vccnz LR15
LD15:
s_mov_b64 exec, -1
s_nop 3
v_add_f32_dpp v88, v92, v88 row_ror:8 row_mask:0xf bank_mask:0x3
v_add_f32_dpp v89, v93, v89 row_ror:8 row_mask:0xf bank_mask:0x3
v_add_f32_dpp v90, v94, v90 row_ror:8 row_mask:0xf bank_mask:0x3
v_add_f32_dpp v91, v95, v91 row_ror:8 row_mask:0xf bank_mask:0x3
v_add_f32_dpp v88, v96, v100 row_ror:8 row_mask:0xf bank_mask:0xc
v_add_f32_dpp v89, v97, v101 row_ror:8 row_mask:0xf bank_mask:0xc
v_add_f32_dpp v90, v98, v102 row_ror:8 row_mask:0xf bank_mask:0xc
v_add_f32_dpp v91, v99, v103 row_ror:8 row_mask:0xf bank_mask:0xc
ds_write_b128 v157, v[88:91]
s_waitcnt lgkmcnt(0)
s_barrier
s_cmp_lg_u32 s62, 0
s_cbranch_scc1 L_fin
ds_read_b32 v4, v159
s_waitcnt lgkmcnt(0)
v_readfirstlane_b32 s62, v4
s_nop 0
s_cmp_eq_u32 s62, 0
s_cbranch_scc1 L_fin
v_add_u32 v104, 55296, v104
v_add_u32 v105, 55296, v105
v_add_u32 v106, 55296, v106
v_add_u32 v107, 55296, v107
s_branch L_f2p
L_f2e:
s_and_b32 s56, s3, 1
s_lshl_b32 s57, s56, 5
s_add_u32 s51, s51, s57
v_lshlrev_b32 v104, 7, v6
v_add_u32 v104, 2813952, v104
v_mul_u32_u24 v105, 1280, v6
v_lshl_add_u32 v106, v2, 3, s51
v_add_u32 v105, v105, v106
v_add_u32 v105, 2803712, v105
s_lshl_b32 s56, s56, 7
s_add_u32 s56, s56, 131072
v_lshl_add_u32 v107, v2, 8, s56
v_lshl_add_u32 v107, v7, 12, v107
s_mov_b32 s18, 0x00ff00ff
s_mov_b32 s19, 0x00ff00ff
s_setprio 0
s_barrier
s_barrier
global_load_dwordx4 v[60:63], v104, s[40:41] sc1
global_load_dwordx2 v[58:59], v105, s[40:41] sc1
LW16:
s_waitcnt vmcnt(0)
LV16:
v_max_u32 v114, v58, v59
v_max3_u32 v114, v114, v60, v61
v_max3_u32 v114, v114, v62, v63
v_cmp_eq_u32 vcc, -1, v114
s_cbranch_vccnz LR16
LD16:
s_mov_b64 exec, -1
v_cmp_lt_u32 vcc, 15, v62
v_lshlrev_b32 v64, 16, v58
v_and_b32 v65, 0xffff0000, v58
v_mov_b32 v4, vcc_lo
ds_write_b32 v159, v4
v_lshlrev_b32 v66, 16, v59
v_and_b32 v67, 0xffff0000, v59
v_and_b32 v60, 2047, v60
v_mul_u32_u24 v60, 1280, v60
v_add_u32 v60, v60, v106
s_waitcnt lgkmcnt(0)
s_cbranch_vccz L_hit
v_mov_b32 v62, v6
s_barrier
L_hit:
v_lshrrev_b32 v4, 3, v62
v_cmp_eq_u32 vcc, s53, v4
v_and_b32 v62, 7, v62
v_lshl_add_u32 v62, v62, 4, v107
s_and_b64 s[18:19], s[18:19], vcc
s_barrier
ds_read_b128 v[72:75], v62 offset:0
ds_read_b128 v[76:79], v62 offset:1024
ds_read_b128 v[80:83], v62 offset:2048
ds_read_b128 v[84:87], v62 offset:3072
s_waitcnt lgkmcnt(0)
v_pk_add_f32 v[72:73], v[72:73], v[76:77]
v_pk_add_f32 v[74:75], v[74:75], v[78:79]
v_pk_add_f32 v[80:81], v[80:81], v[84:85]
v_pk_add_f32 v[82:83], v[82:83], v[86:87]
v_pk_add_f32 v[72:73], v[72:73], v[80:81]
v_pk_add_f32 v[74:75], v[74:75], v[82:83]
s_nop 0
v_add_f32_dpp v72, v72, v72 row_ror:8 row_mask:0xf bank_mask:0xf
v_add_f32_dpp v73, v73, v73 row_ror:8 row_mask:0xf bank_mask:0xf
v_add_f32_dpp v74, v74, v74 row_ror:8 row_mask:0xf bank_mask:0xf
v_add_f32_dpp v75, v75, v75 row_ror:8 row_mask:0xf bank_mask:0xf
v_fma_f32 v72, v72, v61, v64
v_fma_f32 v73, v73, v61, v65
v_fma_f32 v74, v74, v61, v66
v_fma_f32 v75, v75, v61, v67
v_cvt_pk_bf16_f32 v72, v72, v73
v_cvt_pk_bf16_f32 v73, v74, v75
s_mov_b64 exec, s[18:19]
s_cbranch_execz L_f2z
global_store_dwordx2 v60, v[72:73], s[36:37]
L_f2z:
s_mov_b64 exec, -1
L_fin:
L_end:
s_endpgm
LR4:
s_add_u32 s15, s15, 1
s_cmp_lt_u32 s15, 40000
s_cbranch_scc0 LD4
s_mov_b64 exec, vcc
s_sleep 1
global_load_dword v20, v18, s[40:41] sc1
s_branch LW4
LR5:
s_add_u32 s15, s15, 1
s_cmp_lt_u32 s15, 40000
s_cbranch_scc0 LD5
s_mov_b64 exec, vcc
s_sleep 1
global_load_dword v20, v4, s[40:41] offset:0 sc1
s_branch LW5
LR6:
s_add_u32 s15, s15, 1
s_cmp_lt_u32 s15, 40000
s_cbranch_scc0 LD6
s_mov_b64 exec, vcc
s_sleep 1
global_load_dword v20, v4, s[40:41] offset:3072 sc1
s_branch LW6
LR7:
s_add_u32 s15, s15, 1
s_cmp_lt_u32 s15, 40000
s_cbranch_scc0 LD7
s_mov_b64 exec, vcc
s_sleep 1
global_load_dword v20, v4, s[40:41] sc1
s_branch LW7
LR8:
s_add_u32 s15, s15, 1
s_cmp_lt_u32 s15, 40000
s_cbranch_scc0 LD8
s_mov_b64 exec, vcc
s_sleep 1
global_load_dword v20, v4, s[40:41] offset:3072 sc1
s_branch LW8
LR9:
s_add_u32 s15, s15, 1
s_cmp_lt_u32 s15, 40000
s_cbranch_scc0 LD9
s_mov_b64 exec, vcc
s_sleep 1
global_load_dword v20, v4, s[40:41] sc1
s_branch LW9
LR10:
s_add_u32 s15, s15, 1
s_cmp_lt_u32 s15, 40000
s_cbranch_scc0 LD10
s_mov_b64 exec, vcc
s_sleep 1
global_load_dword v20, v7, s[40:41] sc1
s_branch LW10
LR11:
s_add_u32 s15, s15, 1
s_cmp_lt_u32 s15, 40000
s_cbranch_scc0 LD11
s_mov_b64 exec, vcc
s_sleep 2
global_load_dword v20, v4, s[40:41] sc1
s_branch LW11
LR12:
s_add_u32 s15, s15, 1
s_cmp_lt_u32 s15, 40000
s_cbranch_scc0 LD12
s_mov_b64 exec, vcc
s_sleep 1
global_load_dword v20, v4, s[40:41] offset:0 sc1
s_branch LW12
LR13:
s_add_u32 s15, s15, 1
s_cmp_lt_u32 s15, 40000
s_cbranch_scc0 LD13
s_mov_b64 exec, vcc
s_sleep 1
global_load_dwordx4 v[8:11], v120, s[40:41] sc1
s_branch LW13
LR14:
s_add_u32 s15, s15, 1
s_cmp_lt_u32 s15, 40000
s_cbranch_scc0 LD14
s_mov_b64 exec, vcc
s_sleep 1
global_load_dword v20, v4, s[40:41] offset:3072 sc1
s_branch LW14
L_f1h:
s_cmp_ge_u32 s49, 8
s_cbranch_scc1 L_f1q
s_mov_b64 exec, 1
global_load_dword v150, v161, s[40:41] sc1
s_waitcnt vmcnt(0)
global_store_dword v167, v167, s[40:41] sc1
s_mov_b64 exec, -1
s_branch L_f1q
L_st:
global_load_dwordx2 v[150:151], v161, s[40:41] sc1
s_add_u32 s15, s15, 1
s_cmp_lt_u32 s15, 40000
s_waitcnt vmcnt(0)
v_cmp_u_f32 vcc, v150, v151
s_cbranch_scc0 L_su
s_cbranch_vccnz L_st
L_su:
v_mul_f32 v88, s22, v150
v_fma_f32 v90, v151, s22, v158
v_fma_f32 v91, -v88, v88, v90
v_max_f32 v91, v91, v158
v_rsq_f32 v89, v91
v_rcp_f32 v91, v91
v_mul_f32 v89, 0xbfb8aa3b, v89
s_branch L_std
L_p4r:
s_add_u32 s15, s15, 1
s_cmp_lt_u32 s15, 40000
s_cbranch_scc0 L_p4s
s_and_b32 s16, vcc_lo, s20
L_p4t:
s_ff1_i32_b32 s18, s16
s_bitset0_b32 s16, s18
s_mulk_i32 s18, 1312
v_add_u32 v4, s18, v160
s_add_u32 m0, s18, 82048
s_nop 0
global_load_lds_dwordx4 v4, s[40:41] sc1
global_load_lds_dwordx4 v4, s[40:41] offset:256 sc1
s_cmp_lg_u32 s16, 0
s_cbranch_scc1 L_p4t
s_waitcnt vmcnt(0)
s_branch L_p4
LR15:
s_add_u32 s15, s15, 1
s_cmp_lt_u32 s15, 40000
s_cbranch_scc0 LD15
s_mov_b64 exec, vcc
s_sleep 2
global_load_dwordx4 v[72:75], v104, s[40:41] sc1
global_load_dwordx4 v[76:79], v105, s[40:41] sc1
global_load_dwordx4 v[80:83], v106, s[40:41] sc1
global_load_dwordx4 v[84:87], v107, s[40:41] sc1
s_branch LW15
LR16:
s_add_u32 s15, s15, 1
s_cmp_lt_u32 s15, 40000
s_cbranch_scc0 LD16
s_mov_b64 exec, vcc
s_sleep 2
global_load_dwordx4 v[60:63], v104, s[40:41] sc1
global_load_dwordx2 v[58:59], v105, s[40:41] sc1
s_branch LW16
.p2align 7
.type T_0,@object
T_0:
.long 0x4802fe,0xd80090,0x29c0254,0x5820034,0x3b603fe,0x326036e,0x176012e,0x20601be,0x4dc0524,0x44c0494,0x0,0x0,0x1680120,0x1f801b0,0x4f2053a,0x46204aa
.long 0x7a0028,0x10a00c2,0x296024e,0x5880308,0x3bc0404,0x32c0374,0x0,0x0,0x2880240,0x5960010,0x3d2041a,0x342038a,0x19a0152,0x22a01e2,0x4f80540,0x46804b0
.long 0x7402f2,0x10400bc,0x0,0x0,0x506054e,0x47604be,0x5e0024,0xee00a6,0x2ba0272,0x564003a,0x3d80420,0x3480390,0x194014c,0x22401dc,0x0,0x0
.long 0x3e6042e,0x356039e,0x17e0136,0x20e01c6,0x4d4051c,0x444048c,0x6002de,0xf000a8,0x2b4026c,0x56a0302,0x0,0x0,0x4a0000,0xda0092,0x29e0256,0x5800036
.long 0x3b403fc,0x324036c,0x1800138,0x21001c8,0x4da0522,0x44a0492,0x0,0x0,0x16a0122,0x1fa01b2,0x4f00538,0x46004a8,0x7c002a,0x10c00c4,0x2a00258,0x57e02ee
.long 0x3ba0402,0x32a0372,0x0,0x0,0x28a0242,0x5940012,0x3d00418,0x3400388,0x19c0154,0x22c01e4,0x4ee0536,0x45e04a6,0x7602f0,0x10600be,0x0,0x0
.long 0x504054c,0x47404bc,0x680026,0xf800b0,0x2bc0274,0x562003c,0x3ce0416,0x33e0386,0x196014e,0x22601de,0x0,0x0,0x3e4042c,0x354039c,0x1880140,0x21801d0
.long 0x4d2051a,0x442048a,0x6202dc,0xf200aa,0x2b6026e,0x5680300,0x0,0x0,0x4c0002,0xdc0094,0x2a80260,0x5760018,0x3b203fa,0x322036a,0x182013a,0x21201ca
.long 0x4d80520,0x4480490,0x0,0x0,0x16c0124,0x1fc01b4,0x4e6052e,0x456049e,0x7e002c,0x10e00c6,0x2a2025a,0x57c02ec,0x3b80400,0x3280370,0x0,0x0
.long 0x28c0244,0x5920014,0x3c6040e,0x336037e,0x19e0156,0x22e01e6,0x4ec0534,0x45c04a4,0x8002d6,0x11000c8,0x0,0x0,0x502054a,0x47204ba,0x6a0008,0xfa00b2
.long 0x2be0276,0x560003e,0x3cc0414,0x33c0384,0x1a00158,0x23001e8,0x0,0x0,0x3e2042a,0x352039a,0x18a0142,0x21a01d2,0x4d00518,0x4400488,0x6402da,0xf400ac
.long 0x2c00278,0x55e02e6,0x0,0x0,0x4e0004,0xde0096,0x2aa0262,0x574001a,0x3b003f8,0x3200368,0x184013c,0x21401cc,0x4ce0516,0x43e0486,0x0,0x0
.long 0x16e0126,0x1fe01b6,0x4e4052c,0x454049c,0x50002e,0xe00098,0x2a4025c,0x57a02ea,0x3ae03f6,0x31e0366,0x0,0x0,0x28e0246,0x5900016,0x3c4040c,0x334037c
.long 0x1700128,0x20001b8,0x4ea0532,0x45a04a2,0x8202d4,0x11200ca,0x0,0x0,0x5000548,0x47004b8,0x6c000a,0xfc00b4,0x2900248,0x58e030e,0x3ca0412,0x33a0382
.long 0x1a2015a,0x23201ea,0x0,0x0,0x3e00428,0x3500398,0x18c0144,0x21c01d4,0x4fe0546,0x46e04b6,0x6602d8,0xf600ae,0x2c2027a,0x55c02e4,0x0,0x0
.long 0x580006,0xe800a0,0x2ac0264,0x572001c,0x3de0426,0x34e0396,0x186013e,0x21601ce,0x4cc0514,0x43c0484,0x0,0x0,0x1780130,0x20801c0,0x4e2052a,0x452049a
.long 0x5202fc,0xe2009a,0x2a6025e,0x57802e8,0x3ac03f4,0x31c0364,0x0,0x0,0x2980250,0x5860030,0x3c2040a,0x332037a,0x172012a,0x20201ba,0x4e80530,0x45804a0
.long 0x8402d2,0x11400cc,0x0,0x0,0x4f6053e,0x46604ae,0x6e000c,0xfe00b6,0x292024a,0x58c030c,0x3c80410,0x3380380,0x1a4015c,0x23401ec,0x0,0x0
.long 0x3d6041e,0x346038e,0x18e0146,0x21e01d6,0x4fc0544,0x46c04b4,0x7002f6,0x10000b8,0x2c4027c,0x55a02e2,0x0,0x0,0x5a0020,0xea00a2,0x2ae0266,0x570001e
.long 0x3dc0424,0x34c0394,0x1900148,0x22001d8,0x4ca0512,0x43a0482,0x0,0x0,0x17a0132,0x20a01c2,0x4e00528,0x4500498,0x5402fa,0xe4009c,0x2b00268,0x56e0306
.long 0x3aa03f2,0x31a0362,0x0,0x0,0x29a0252,0x5840032,0x3c00408,0x3300378,0x174012c,0x20401bc,0x4de0526,0x44e0496,0x8602d0,0x11600ce,0x0,0x0
.long 0x4f4053c,0x46404ac,0x78000e,0x10800c0,0x294024c,0x58a030a,0x3be0406,0x32e0376,0x1a6015e,0x23601ee,0x0,0x0,0x3d4041c,0x344038c,0x1980150,0x22801e0
.long 0x4fa0542,0x46a04b2,0x7202f4,0x10200ba,0x2c6027e,0x55802e0,0x0,0x0,0x5c0022,0xec00a4,0x2b80270,0x5660038,0x3da0422,0x34a0392,0x192014a,0x22201da
.long 0x4c80510,0x4380480,0x0,0x0,0x17c0134,0x20c01c4,0x4d6051e,0x446048e,0x5602f8,0xe6009e,0x2b2026a,0x56c0304,0x3a803f0,0x3180360,0x0,0x0
.long 0x2400040,0xc000800,0x14001000,0x1c001800,0x24002000,0x2c002800,0x34003000,0x3c003800,0x44004000,0x4c004800,0x5c007c0,0x9bc09fc0,0x93c097c0,0x8bc08fc0,0x83c087c0,0x7bc07fc0
.long 0x73c077c0,0x6bc06fc0,0x63c067c0,0x5bc05fc0,0x2800080,0xc400840,0x14401040,0x1c401840,0x24402040,0x2c402840,0x34403040,0x3c403840,0x44404040,0x4c404840,0x5800780,0x9b809f80
.long 0x93809780,0x8b808f80,0x83808780,0x7b807f80,0x73807780,0x6b806f80,0x63806780,0x5b805f80,0x2c000c0,0xc800880,0x14801080,0x1c801880,0x24802080,0x2c802880,0x34803080,0x3c803880
.long 0x44804080,0x4c804880,0x5400740,0x9b409f40,0x93409740,0x8b408f40,0x83408740,0x7b407f40,0x73407740,0x6b406f40,0x63406740,0x5b405f40,0x3000100,0xcc008c0,0x14c010c0,0x1cc018c0
.long 0x24c020c0,0x2cc028c0,0x34c030c0,0x3cc038c0,0x44c040c0,0x4cc048c0,0x5000700,0x9b009f00,0x93009700,0x8b008f00,0x83008700,0x7b007f00,0x73007700,0x6b006f00,0x63006700,0x5b005f00
.long 0x52005000,0xd000900,0x15001100,0x1d001900,0x25002100,0x2d002900,0x35003100,0x3d003900,0x45004100,0x4d004900,0x55c057c0,0x9ac09ec0,0x92c096c0,0x8ac08ec0,0x82c086c0,0x7ac07ec0
.long 0x72c076c0,0x6ac06ec0,0x62c066c0,0x5ac05ec0,0x52405040,0xd400940,0x15401140,0x1d401940,0x25402140,0x2d402940,0x35403140,0x3d403940,0x45404140,0x4d404940,0x55805780,0x9a809e80
.long 0x92809680,0x8a808e80,0x82808680,0x7a807e80,0x72807680,0x6a806e80,0x62806680,0x5a805e80,0x52805080,0xd800980,0x15801180,0x1d801980,0x25802180,0x2d802980,0x35803180,0x3d803980
.long 0x45804180,0x4d804980,0x55405740,0x9a409e40,0x92409640,0x8a408e40,0x82408640,0x7a407e40,0x72407640,0x6a406e40,0x62406640,0x5a405e40,0x52c050c0,0xdc009c0,0x15c011c0,0x1dc019c0
.long 0x25c021c0,0x2dc029c0,0x35c031c0,0x3dc039c0,0x45c041c0,0x4dc049c0,0x55005700,0x9a009e00,0x92009600,0x8a008e00,0x82008600,0x7a007e00,0x72007600,0x6a006e00,0x62006600,0x5a005e00
.long 0x3400140,0xe000a00,0x16001200,0x1e001a00,0x26002200,0x2e002a00,0x36003200,0x3e003a00,0x46004200,0x4e004a00,0x4c006c0,0x99c09dc0,0x91c095c0,0x89c08dc0,0x81c085c0,0x79c07dc0
.long 0x71c075c0,0x69c06dc0,0x61c065c0,0x59c05dc0,0x3800180,0xe400a40,0x16401240,0x1e401a40,0x26402240,0x2e402a40,0x36403240,0x3e403a40,0x46404240,0x4e404a40,0x4800680,0x99809d80
.long 0x91809580,0x89808d80,0x81808580,0x79807d80,0x71807580,0x69806d80,0x61806580,0x59805d80,0x3c001c0,0xe800a80,0x16801280,0x1e801a80,0x26802280,0x2e802a80,0x36803280,0x3e803a80
.long 0x46804280,0x4e804a80,0x4400640,0x99409d40,0x91409540,0x89408d40,0x81408540,0x79407d40,0x71407540,0x69406d40,0x61406540,0x59405d40,0x4000200,0xec00ac0,0x16c012c0,0x1ec01ac0
.long 0x26c022c0,0x2ec02ac0,0x36c032c0,0x3ec03ac0,0x46c042c0,0x4ec04ac0,0x600,0x99009d00,0x91009500,0x89008d00,0x81008500,0x79007d00,0x71007500,0x69006d00,0x61006500,0x59005d00
.long 0x53005100,0xf000b00,0x17001300,0x1f001b00,0x27002300,0x2f002b00,0x37003300,0x3f003b00,0x47004300,0x4f004b00,0x54c056c0,0x98c09cc0,0x90c094c0,0x88c08cc0,0x80c084c0,0x78c07cc0
.long 0x70c074c0,0x68c06cc0,0x60c064c0,0x58c05cc0,0x53405140,0xf400b40,0x17401340,0x1f401b40,0x27402340,0x2f402b40,0x37403340,0x3f403b40,0x47404340,0x4f404b40,0x54805680,0x98809c80
.long 0x90809480,0x88808c80,0x80808480,0x78807c80,0x70807480,0x68806c80,0x60806480,0x58805c80,0x53805180,0xf800b80,0x17801380,0x1f801b80,0x27802380,0x2f802b80,0x37803380,0x3f803b80
.long 0x47804380,0x4f804b80,0x54405640,0x98409c40,0x90409440,0x88408c40,0x80408440,0x78407c40,0x70407440,0x68406c40,0x60406440,0x58405c40,0x53c051c0,0xfc00bc0,0x17c013c0,0x1fc01bc0
.long 0x27c023c0,0x2fc02bc0,0x37c033c0,0x3fc03bc0,0x47c043c0,0x4fc04bc0,0x54005600,0x98009c00,0x90009400,0x88008c00,0x80008400,0x78007c00,0x70007400,0x68006c00,0x60006400,0x58005c00
.long 0x0,0x0,0x0,0x0,0x0,0x0,0x0,0x0,0x0,0x0,0x0,0x0,0x0,0x0,0x0,0x0
.long 0x0,0x0,0x0,0x0,0x0,0x0,0x0,0x0,0x0,0x0,0x0,0x0,0x0,0x0,0x0,0x0
.long 0x0,0x0,0x0,0x0,0x0,0x0,0x0,0x0,0x0,0x0,0x0,0x0,0x0,0x0,0x0,0x0
.long 0x0,0x0,0x0,0x0,0x0,0x0,0x0,0x0,0x0,0x0,0x0,0x0,0x0,0x0,0x0,0x0
T_end:
.section .rodata,"a"
.p2align 6
.amdhsa_kernel sequential_preLN__spectral_fnet__moe_arch_mod__prompt_kernel
  .amdhsa_next_free_vgpr 168
  .amdhsa_next_free_sgpr 102
  .amdhsa_accum_offset 168
  .amdhsa_group_segment_fixed_size 0
  .amdhsa_kernarg_size 104
  .amdhsa_user_sgpr_count 2
  .amdhsa_user_sgpr_kernarg_segment_ptr 1
  .amdhsa_system_sgpr_workgroup_id_x 1
.end_amdhsa_kernel
```
